```python
import torch

def _softmax(x, axis=-1):
    return torch.softmax(x, dim=axis)
def _gelu(x):
    return torch.nn.functional.gelu(x, approximate="tanh")
def _silu(x):
    return torch.nn.functional.silu(x)
def _sigmoid(x):
    return torch.sigmoid(x)
def _layernorm(x, axis=-1, eps=1e-5):
    m = x.mean(dim=axis, keepdim=True)
    v = x.var(dim=axis, keepdim=True, unbiased=False)
    return (x - m) / torch.sqrt(v + eps)
def _scatter_add(tgt, idx, src, axis=0):
    return tgt.clone().index_add_(axis, idx, src)
def _segment_sum(src, seg, n):
    out = torch.zeros((n,) + src.shape[1:], dtype=src.dtype)
    return out.index_add_(0, seg, src)
def _pad(x, pw):
    flat = tuple(v for pair in reversed(pw) for v in pair)
    return torch.nn.functional.pad(x, flat)

kernel_name = 'recurrent_scan__gqa_block_cached__mixer_channel_mlp__decode'

def setup_inputs():

    _w = (lambda a: (lambda t: t.to(torch.bfloat16) if t.is_floating_point() else t)(torch.as_tensor(a)))
    def _A_setup():
        B, Sq, D = 4, 1, 512
        Hq, Hkv, Sk, Dh = 32, 8, 8192, 128
        assert Hq % Hkv == 0, (Hq, Hkv)
        return {
            "x": _w((lambda *s: torch.randn(*s, dtype=torch.bfloat16) * 0.1)(B, Sq, D)),
            "k_cache": _w((lambda *s: torch.randn(*s, dtype=torch.bfloat16) * 0.8)(B, Hkv, Sk, Dh)),
            "v_cache": _w((lambda *s: torch.randn(*s, dtype=torch.bfloat16) * 3.2)(B, Hkv, Sk, Dh)),
            "wq": _w((lambda *s: torch.randn(*s, dtype=torch.bfloat16) * 0.8)(D, Hq * Dh) * (D ** -0.5)),
            "wo": _w((lambda *s: torch.randn(*s, dtype=torch.bfloat16) * 3.2)(Hq * Dh, D) * ((Hq * Dh) ** -0.5)),
        }
    _A_in = _A_setup()

    def _B_setup():
        B, S, D, F = 4, 1, 512, 1792
        return {
            "x": _w((lambda *s: torch.randn(*s, dtype=torch.bfloat16) * 0.1)(B, S, D)),
            "w1": _w((lambda *s: torch.randn(*s, dtype=torch.bfloat16) * 3.2)(D, F) * (D ** -0.5)),
            "b1": _w((lambda *s: torch.randn(*s, dtype=torch.bfloat16) * 3.2)(F)),
            "w2": _w((lambda *s: torch.randn(*s, dtype=torch.bfloat16) * 3.2)(F, D) * (F ** -0.5)),
            "b2": _w((lambda *s: torch.randn(*s, dtype=torch.bfloat16) * 3.2)(D)),
        }
    _B_in = _B_setup()

    return {
        "A_x": _A_in["x"],
        "A_k_cache": _A_in["k_cache"],
        "A_v_cache": _A_in["v_cache"],
        "A_wq": _A_in["wq"],
        "A_wo": _A_in["wo"],
        "B_x": _B_in["x"],
        "B_w1": _B_in["w1"],
        "B_b1": _B_in["b1"],
        "B_w2": _B_in["w2"],
        "B_b2": _B_in["b2"],
    }

def reference(A_x, A_k_cache, A_v_cache, A_wq, A_wo, B_x, B_w1, B_b1, B_w2, B_b2):
    def _A_ref(x, k_cache, v_cache, wq, wo):
        B, Sq, D = x.shape
        Hq, Dh = 32, 128
        Hkv = k_cache.shape[1]
        rep = Hq // Hkv
        q = (lambda x, *d: x.permute(*d))((x @ wq).reshape(B, Sq, Hq, Dh), 0, 2, 1, 3)
        k = (lambda x, n, axis: torch.repeat_interleave(x, n, dim=axis))(k_cache, rep, axis=1)
        v = (lambda x, n, axis: torch.repeat_interleave(x, n, dim=axis))(v_cache, rep, axis=1)
        scores = torch.einsum("bhqd,bhkd->bhqk", q, k) * (Dh ** -0.5)
        p = _softmax(scores, axis=-1)
        o = torch.einsum("bhqk,bhkd->bhqd", p, v)
        return (lambda x, *d: x.permute(*d))(o, 0, 2, 1, 3).reshape(B, Sq, Hq * Dh) @ wo

    def _B_ref(x, w1, b1, w2, b2):
        y = _layernorm(x, axis=-1)
        h = _gelu(torch.einsum("bsd,df->bsf", y, w1) + b1)
        return torch.einsum("bsf,fd->bsd", h, w2) + b2

    x = A_x
    xn = _layernorm(x, axis=-1)
    s = _A_ref(xn, A_k_cache, A_v_cache, A_wq, A_wo)
    g = _silu(_B_ref(xn, B_w1, B_b1, B_w2, B_b2))
    return x + s * g
```

```asm
; @launch grid=(256,1,1) block=(320,1,1) lds=51200
.amdgcn_target "amdgcn-amd-amdhsa--gfx950"
.text
.globl recurrent_scan__gqa_block_cached__mixer_channel_mlp__decode_kernel
.p2align 8
.type recurrent_scan__gqa_block_cached__mixer_channel_mlp__decode_kernel,@function
recurrent_scan__gqa_block_cached__mixer_channel_mlp__decode_kernel:
  s_load_dwordx2 s[8:9], s[0:1], 8
  s_load_dwordx2 s[12:13], s[0:1], 16
  s_load_dwordx2 s[24:25], s[0:1], 0
  s_load_dwordx2 s[28:29], s[0:1], 24
  s_load_dwordx2 s[20:21], s[0:1], 96
  s_cmp_ge_u32 s2, 0x100
  s_cbranch_scc1 L_end
  v_lshrrev_b32 v1, 6, v0
  v_and_b32 v0, 63, v0
  v_readfirstlane_b32 s3, v1
  s_and_b32 s4, s2, 7
  s_lshr_b32 s5, s2, 3
  s_lshr_b32 s6, s2, 6
  s_and_b32 s7, s5, 7
  s_cmp_eq_u32 s3, 0
  s_cbranch_scc1 L_helper
  s_mov_b32 s10, 0x4000000
  s_mov_b32 s11, 0x20000
  s_mov_b32 s14, 0x4000000
  s_mov_b32 s15, 0x20000
  s_lshl_b32 s38, s6, 3
  s_add_u32 s38, s38, s4
  s_lshl_b32 s39, s38, 21
  s_lshl_b32 s40, s7, 2
  s_add_u32 s40, s40, s3
  s_lshl_b32 s40, s40, 12
  s_add_u32 s39, s39, s40
  s_sub_u32 s39, s39, 0x1000
  s_mul_i32 s37, s38, 98304
  s_add_u32 s37, s37, s39
  s_lshl_b32 s45, s38, 21
  s_and_b32 s39, s37, 0x1fffff
  s_or_b32 s39, s39, s45
  v_bfe_u32 v1, v0, 2, 2
  v_lshrrev_b32 v23, 4, v0
  v_lshlrev_b32 v1, 8, v1
  v_lshl_or_b32 v1, v23, 6, v1
  v_and_b32 v19, 3, v0
  v_lshl_or_b32 v1, v19, 4, v1
  v_lshlrev_b32 v2, 4, v0
  s_waitcnt lgkmcnt(0)
  buffer_load_dwordx4 v[64:67], v1, s[8:11], s39 offen offset:0 nt
  buffer_load_dwordx4 v[68:71], v1, s[8:11], s39 offen offset:1024 nt
  buffer_load_dwordx4 v[72:75], v1, s[8:11], s39 offen offset:2048 nt
  buffer_load_dwordx4 v[76:79], v1, s[8:11], s39 offen offset:3072 nt
  buffer_load_dwordx4 v[80:83], v2, s[12:15], s39 offen offset:0 nt
  s_setprio 2
  s_load_dwordx2 s[16:17], s[0:1], 32
  s_mov_b32 s18, 0x400000
  s_mov_b32 s19, 0x20000
  s_mov_b32 s22, 0x10000000
  s_mov_b32 s23, 0x20000
  v_mov_b32 v20, 0x3e0293ee
  v_mov_b32 v46, 0xffff
  v_and_b32 v22, 1, v0
  v_lshlrev_b32 v22, 4, v22
  v_lshlrev_b32 v46, v22, v46
  v_cmp_gt_u32 vcc, 2, v19
  s_nop 1
  v_cndmask_b32 v21, 0, v46, vcc
  v_sub_u32 v22, v46, v21
  v_mov_b32 v28, 0
  v_mov_b32 v29, 0
  v_mov_b32 v32, 0
  v_mov_b32 v33, 0
  v_mov_b32 v36, 0
  v_mov_b32 v37, 0
  v_mov_b32 v40, 0
  v_mov_b32 v41, 0
  v_mov_b32 v44, 0
  v_mov_b32 v45, 0
  v_and_b32 v3, 15, v0
  v_lshlrev_b32 v3, 4, v3
  v_lshl_or_b32 v3, v23, 10, v3
  s_lshl_b32 s40, s4, 3
  s_add_u32 s40, s40, s7
  s_lshl_b32 s40, s40, 16
  s_lshl_b32 s41, s3, 8
  s_add_u32 s40, s40, s41
  s_sub_u32 s40, s40, 0x100
  s_mov_b32 s34, 0x05040100
  s_mov_b32 s35, 0x07060302
  s_mov_b32 s36, 0x3ff
  s_waitcnt vmcnt(4)
  buffer_load_dwordx4 v[84:87], v2, s[12:15], s39 offen offset:1024 nt
  s_waitcnt vmcnt(4)
  buffer_load_dwordx4 v[88:91], v2, s[12:15], s39 offen offset:2048 nt
  s_waitcnt vmcnt(4)
  buffer_load_dwordx4 v[92:95], v2, s[12:15], s39 offen offset:3072 nt
  s_add_u32 s39, s39, 0x20000
  s_and_b32 s39, s39, 0x1fffff
  s_or_b32 s39, s39, s45
  s_waitcnt vmcnt(4)
  buffer_load_dwordx4 v[96:99], v1, s[8:11], s39 offen offset:0 nt
  s_waitcnt vmcnt(4)
  buffer_load_dwordx4 v[100:103], v1, s[8:11], s39 offen offset:1024 nt
  s_waitcnt vmcnt(4)
  buffer_load_dwordx4 v[104:107], v1, s[8:11], s39 offen offset:2048 nt
  s_waitcnt vmcnt(4)
  buffer_load_dwordx4 v[108:111], v1, s[8:11], s39 offen offset:3072 nt
  s_waitcnt vmcnt(4)
  buffer_load_dwordx4 v[112:115], v2, s[12:15], s39 offen offset:0 nt
  s_waitcnt vmcnt(4)
  buffer_load_dwordx4 v[116:119], v2, s[12:15], s39 offen offset:1024 nt
  s_waitcnt vmcnt(4)
  buffer_load_dwordx4 v[120:123], v2, s[12:15], s39 offen offset:2048 nt
  s_waitcnt vmcnt(4)
  buffer_load_dwordx4 v[124:127], v2, s[12:15], s39 offen offset:3072 nt
  s_add_u32 s39, s39, 0x20000
  s_and_b32 s39, s39, 0x1fffff
  s_or_b32 s39, s39, s45
  s_waitcnt vmcnt(4)
  buffer_load_dwordx4 v[128:131], v1, s[8:11], s39 offen offset:0 nt
  s_waitcnt vmcnt(4)
  buffer_load_dwordx4 v[132:135], v1, s[8:11], s39 offen offset:1024 nt
  s_waitcnt vmcnt(4)
  buffer_load_dwordx4 v[136:139], v1, s[8:11], s39 offen offset:2048 nt
  s_waitcnt vmcnt(4)
  buffer_load_dwordx4 v[140:143], v1, s[8:11], s39 offen offset:3072 nt
  s_waitcnt vmcnt(4)
  buffer_load_dwordx4 v[144:147], v2, s[12:15], s39 offen offset:0 nt
  s_waitcnt vmcnt(4)
  buffer_load_dwordx4 v[148:151], v2, s[12:15], s39 offen offset:1024 nt
  s_waitcnt vmcnt(4)
  buffer_load_dwordx4 v[152:155], v2, s[12:15], s39 offen offset:2048 nt
  s_waitcnt vmcnt(4)
  buffer_load_dwordx4 v[156:159], v2, s[12:15], s39 offen offset:3072 nt
  s_add_u32 s39, s39, 0x20000
  s_and_b32 s39, s39, 0x1fffff
  s_or_b32 s39, s39, s45
  s_waitcnt vmcnt(4)
  buffer_load_dwordx4 v[160:163], v1, s[8:11], s39 offen offset:0 nt
  s_waitcnt vmcnt(4)
  buffer_load_dwordx4 v[164:167], v1, s[8:11], s39 offen offset:1024 nt
  s_waitcnt vmcnt(4)
  buffer_load_dwordx4 v[168:171], v1, s[8:11], s39 offen offset:2048 nt
  s_waitcnt vmcnt(4)
  buffer_load_dwordx4 v[172:175], v1, s[8:11], s39 offen offset:3072 nt
  s_waitcnt vmcnt(4)
  buffer_load_dwordx4 v[176:179], v2, s[12:15], s39 offen offset:0 nt
  s_waitcnt vmcnt(4)
  buffer_load_dwordx4 v[180:183], v2, s[12:15], s39 offen offset:1024 nt
  s_waitcnt vmcnt(4)
  buffer_load_dwordx4 v[184:187], v2, s[12:15], s39 offen offset:2048 nt
  s_waitcnt vmcnt(4)
  buffer_load_dwordx4 v[188:191], v2, s[12:15], s39 offen offset:3072 nt
  s_add_u32 s39, s39, 0x20000
  s_and_b32 s39, s39, 0x1fffff
  s_or_b32 s39, s39, s45
  s_waitcnt vmcnt(4)
  buffer_load_dwordx4 v[192:195], v1, s[8:11], s39 offen offset:0 nt
  s_waitcnt vmcnt(4)
  buffer_load_dwordx4 v[196:199], v1, s[8:11], s39 offen offset:1024 nt
  s_waitcnt vmcnt(4)
  buffer_load_dwordx4 v[200:203], v1, s[8:11], s39 offen offset:2048 nt
  s_waitcnt vmcnt(4)
  buffer_load_dwordx4 v[204:207], v1, s[8:11], s39 offen offset:3072 nt
  s_waitcnt vmcnt(4)
  buffer_load_dwordx4 v[208:211], v2, s[12:15], s39 offen offset:0 nt
  s_waitcnt vmcnt(4)
  buffer_load_dwordx4 v[212:215], v2, s[12:15], s39 offen offset:1024 nt
  s_waitcnt vmcnt(4)
  buffer_load_dwordx4 v[216:219], v2, s[12:15], s39 offen offset:2048 nt
  s_waitcnt vmcnt(4)
  buffer_load_dwordx4 v[220:223], v2, s[12:15], s39 offen offset:3072 nt
  s_barrier
  ds_read_b128 v[4:7], v2 offset:41472
  ds_read_b32 v47, v28 offset:42496
  ds_read_b32 v46, v28 offset:42500
  s_waitcnt lgkmcnt(0)
  v_readfirstlane_b32 s48, v46
  s_add_u32 s39, s39, 0x20000
  s_and_b32 s39, s39, 0x1fffff
  s_or_b32 s39, s39, s45
  buffer_load_dwordx4 v[224:227], v1, s[8:11], s39 offen offset:0 nt
  s_waitcnt vmcnt(5)
  buffer_load_dwordx4 v[228:231], v1, s[8:11], s39 offen offset:1024 nt
  v_mfma_f32_16x16x32_bf16 v[48:51], v[64:67], v[4:7], 0
  v_mfma_f32_16x16x32_bf16 v[52:55], v[68:71], v[4:7], 0
  v_mfma_f32_16x16x32_bf16 v[56:59], v[72:75], v[4:7], 0
  v_mfma_f32_16x16x32_bf16 v[60:63], v[76:79], v[4:7], 0
  s_nop 4
  v_mul_f32_dpp v24, v48, v20 quad_perm:[0,0,0,0] row_mask:0xf bank_mask:0xf
  v_mul_f32_dpp v25, v52, v20 quad_perm:[0,0,0,0] row_mask:0xf bank_mask:0xf
  v_mul_f32_dpp v26, v56, v20 quad_perm:[0,0,0,0] row_mask:0xf bank_mask:0xf
  v_mul_f32_dpp v27, v60, v20 quad_perm:[0,0,0,0] row_mask:0xf bank_mask:0xf
  v_fmac_f32_dpp v24, v49, v20 quad_perm:[1,1,1,1] row_mask:0xf bank_mask:0xf
  v_fmac_f32_dpp v25, v53, v20 quad_perm:[1,1,1,1] row_mask:0xf bank_mask:0xf
  v_fmac_f32_dpp v26, v57, v20 quad_perm:[1,1,1,1] row_mask:0xf bank_mask:0xf
  v_fmac_f32_dpp v27, v61, v20 quad_perm:[1,1,1,1] row_mask:0xf bank_mask:0xf
  v_fmac_f32_dpp v24, v50, v20 quad_perm:[2,2,2,2] row_mask:0xf bank_mask:0xf
  v_fmac_f32_dpp v25, v54, v20 quad_perm:[2,2,2,2] row_mask:0xf bank_mask:0xf
  v_fmac_f32_dpp v26, v58, v20 quad_perm:[2,2,2,2] row_mask:0xf bank_mask:0xf
  v_fmac_f32_dpp v27, v62, v20 quad_perm:[2,2,2,2] row_mask:0xf bank_mask:0xf
  v_fmac_f32_dpp v24, v51, v20 quad_perm:[3,3,3,3] row_mask:0xf bank_mask:0xf
  v_fmac_f32_dpp v25, v55, v20 quad_perm:[3,3,3,3] row_mask:0xf bank_mask:0xf
  v_fmac_f32_dpp v26, v59, v20 quad_perm:[3,3,3,3] row_mask:0xf bank_mask:0xf
  v_fmac_f32_dpp v27, v63, v20 quad_perm:[3,3,3,3] row_mask:0xf bank_mask:0xf
  v_max3_f32 v23, v24, v25, v26
  v_max_f32 v23, v23, v27
  v_mov_b32 v46, v23
  s_nop 1
  v_permlane16_swap_b32 v23, v46
  v_max_f32 v23, v23, v46
  v_mov_b32 v46, v23
  s_nop 1
  v_permlane32_swap_b32 v23, v46
  v_max_f32 v23, v23, v46
  v_sub_f32 v24, v24, v23
  v_sub_f32 v25, v25, v23
  v_sub_f32 v26, v26, v23
  v_sub_f32 v27, v27, v23
  v_exp_f32 v24, v24
  v_exp_f32 v25, v25
  v_exp_f32 v26, v26
  v_exp_f32 v27, v27
  v_mov_b32 v16, v23
  v_mov_b32 v17, v24
  v_cvt_pk_bf16_f32 v31, v24, v24
  v_and_b32 v30, v21, v31
  v_and_b32 v31, v22, v31
  v_cvt_pk_bf16_f32 v35, v25, v25
  v_add_f32 v17, v17, v25
  v_and_b32 v34, v21, v35
  v_and_b32 v35, v22, v35
  v_cvt_pk_bf16_f32 v39, v26, v26
  v_add_f32 v17, v17, v26
  v_and_b32 v38, v21, v39
  v_and_b32 v39, v22, v39
  v_cvt_pk_bf16_f32 v43, v27, v27
  v_add_f32 v17, v17, v27
  v_and_b32 v42, v21, v43
  v_and_b32 v43, v22, v43
  s_waitcnt vmcnt(5)
  buffer_load_dwordx4 v[232:235], v1, s[8:11], s39 offen offset:2048 nt
  v_mfma_f32_16x16x32_bf16 v[8:11], v[80:83], v[30:33], 0
  v_mfma_f32_16x16x32_bf16 v[12:15], v[80:83], v[28:31], 0
  v_mfma_f32_16x16x32_bf16 v[8:11], v[84:87], v[34:37], v[8:11]
  v_mfma_f32_16x16x32_bf16 v[12:15], v[84:87], v[32:35], v[12:15]
  v_mfma_f32_16x16x32_bf16 v[8:11], v[88:91], v[38:41], v[8:11]
  v_mfma_f32_16x16x32_bf16 v[12:15], v[88:91], v[36:39], v[12:15]
  v_mfma_f32_16x16x32_bf16 v[8:11], v[92:95], v[42:45], v[8:11]
  v_mfma_f32_16x16x32_bf16 v[12:15], v[92:95], v[40:43], v[12:15]
  s_waitcnt vmcnt(5)
  buffer_load_dwordx4 v[236:239], v1, s[8:11], s39 offen offset:3072 nt
  s_waitcnt vmcnt(5)
  buffer_load_dwordx4 v[240:243], v2, s[12:15], s39 offen offset:0 nt
  v_mfma_f32_16x16x32_bf16 v[48:51], v[96:99], v[4:7], 0
  v_mfma_f32_16x16x32_bf16 v[52:55], v[100:103], v[4:7], 0
  v_mfma_f32_16x16x32_bf16 v[56:59], v[104:107], v[4:7], 0
  v_mfma_f32_16x16x32_bf16 v[60:63], v[108:111], v[4:7], 0
  s_nop 4
  v_mul_f32_dpp v24, v48, v20 quad_perm:[0,0,0,0] row_mask:0xf bank_mask:0xf
  v_mul_f32_dpp v25, v52, v20 quad_perm:[0,0,0,0] row_mask:0xf bank_mask:0xf
  v_mul_f32_dpp v26, v56, v20 quad_perm:[0,0,0,0] row_mask:0xf bank_mask:0xf
  v_mul_f32_dpp v27, v60, v20 quad_perm:[0,0,0,0] row_mask:0xf bank_mask:0xf
  v_fmac_f32_dpp v24, v49, v20 quad_perm:[1,1,1,1] row_mask:0xf bank_mask:0xf
  v_fmac_f32_dpp v25, v53, v20 quad_perm:[1,1,1,1] row_mask:0xf bank_mask:0xf
  v_fmac_f32_dpp v26, v57, v20 quad_perm:[1,1,1,1] row_mask:0xf bank_mask:0xf
  v_fmac_f32_dpp v27, v61, v20 quad_perm:[1,1,1,1] row_mask:0xf bank_mask:0xf
  v_fmac_f32_dpp v24, v50, v20 quad_perm:[2,2,2,2] row_mask:0xf bank_mask:0xf
  v_fmac_f32_dpp v25, v54, v20 quad_perm:[2,2,2,2] row_mask:0xf bank_mask:0xf
  v_fmac_f32_dpp v26, v58, v20 quad_perm:[2,2,2,2] row_mask:0xf bank_mask:0xf
  v_fmac_f32_dpp v27, v62, v20 quad_perm:[2,2,2,2] row_mask:0xf bank_mask:0xf
  v_fmac_f32_dpp v24, v51, v20 quad_perm:[3,3,3,3] row_mask:0xf bank_mask:0xf
  v_fmac_f32_dpp v25, v55, v20 quad_perm:[3,3,3,3] row_mask:0xf bank_mask:0xf
  v_fmac_f32_dpp v26, v59, v20 quad_perm:[3,3,3,3] row_mask:0xf bank_mask:0xf
  v_fmac_f32_dpp v27, v63, v20 quad_perm:[3,3,3,3] row_mask:0xf bank_mask:0xf
  v_max3_f32 v23, v24, v25, v26
  v_max3_f32 v23, v23, v27, v16
  v_mov_b32 v46, v23
  s_nop 1
  v_permlane16_swap_b32 v23, v46
  v_max_f32 v23, v23, v46
  v_mov_b32 v46, v23
  s_nop 1
  v_permlane32_swap_b32 v23, v46
  v_max_f32 v23, v23, v46
  v_sub_f32 v18, v16, v23
  v_sub_f32 v24, v24, v23
  v_sub_f32 v25, v25, v23
  v_sub_f32 v26, v26, v23
  v_sub_f32 v27, v27, v23
  v_exp_f32 v18, v18
  v_exp_f32 v24, v24
  v_exp_f32 v25, v25
  v_exp_f32 v26, v26
  v_exp_f32 v27, v27
  v_mov_b32 v16, v23
  v_pk_mul_f32 v[8:9], v[8:9], v[18:19] op_sel_hi:[1,0]
  v_pk_mul_f32 v[10:11], v[10:11], v[18:19] op_sel_hi:[1,0]
  v_pk_mul_f32 v[12:13], v[12:13], v[18:19] op_sel_hi:[1,0]
  v_pk_mul_f32 v[14:15], v[14:15], v[18:19] op_sel_hi:[1,0]
  v_fma_f32 v17, v17, v18, v24
  v_cvt_pk_bf16_f32 v31, v24, v24
  v_and_b32 v30, v21, v31
  v_and_b32 v31, v22, v31
  v_cvt_pk_bf16_f32 v35, v25, v25
  v_add_f32 v17, v17, v25
  v_and_b32 v34, v21, v35
  v_and_b32 v35, v22, v35
  v_cvt_pk_bf16_f32 v39, v26, v26
  v_add_f32 v17, v17, v26
  v_and_b32 v38, v21, v39
  v_and_b32 v39, v22, v39
  v_cvt_pk_bf16_f32 v43, v27, v27
  v_add_f32 v17, v17, v27
  v_and_b32 v42, v21, v43
  v_and_b32 v43, v22, v43
  s_waitcnt vmcnt(5)
  buffer_load_dwordx4 v[244:247], v2, s[12:15], s39 offen offset:1024 nt
  v_mfma_f32_16x16x32_bf16 v[8:11], v[112:115], v[30:33], v[8:11]
  v_mfma_f32_16x16x32_bf16 v[12:15], v[112:115], v[28:31], v[12:15]
  v_mfma_f32_16x16x32_bf16 v[8:11], v[116:119], v[34:37], v[8:11]
  v_mfma_f32_16x16x32_bf16 v[12:15], v[116:119], v[32:35], v[12:15]
  v_mfma_f32_16x16x32_bf16 v[8:11], v[120:123], v[38:41], v[8:11]
  v_mfma_f32_16x16x32_bf16 v[12:15], v[120:123], v[36:39], v[12:15]
  v_mfma_f32_16x16x32_bf16 v[8:11], v[124:127], v[42:45], v[8:11]
  v_mfma_f32_16x16x32_bf16 v[12:15], v[124:127], v[40:43], v[12:15]
  s_waitcnt vmcnt(5)
  buffer_load_dwordx4 v[248:251], v2, s[12:15], s39 offen offset:2048 nt
  s_waitcnt vmcnt(5)
  buffer_load_dwordx4 v[252:255], v2, s[12:15], s39 offen offset:3072 nt
  v_mfma_f32_16x16x32_bf16 v[48:51], v[128:131], v[4:7], 0
  v_mfma_f32_16x16x32_bf16 v[52:55], v[132:135], v[4:7], 0
  v_mfma_f32_16x16x32_bf16 v[56:59], v[136:139], v[4:7], 0
  v_mfma_f32_16x16x32_bf16 v[60:63], v[140:143], v[4:7], 0
  s_nop 4
  v_mul_f32_dpp v24, v48, v20 quad_perm:[0,0,0,0] row_mask:0xf bank_mask:0xf
  v_mul_f32_dpp v25, v52, v20 quad_perm:[0,0,0,0] row_mask:0xf bank_mask:0xf
  v_mul_f32_dpp v26, v56, v20 quad_perm:[0,0,0,0] row_mask:0xf bank_mask:0xf
  v_mul_f32_dpp v27, v60, v20 quad_perm:[0,0,0,0] row_mask:0xf bank_mask:0xf
  v_fmac_f32_dpp v24, v49, v20 quad_perm:[1,1,1,1] row_mask:0xf bank_mask:0xf
  v_fmac_f32_dpp v25, v53, v20 quad_perm:[1,1,1,1] row_mask:0xf bank_mask:0xf
  v_fmac_f32_dpp v26, v57, v20 quad_perm:[1,1,1,1] row_mask:0xf bank_mask:0xf
  v_fmac_f32_dpp v27, v61, v20 quad_perm:[1,1,1,1] row_mask:0xf bank_mask:0xf
  v_fmac_f32_dpp v24, v50, v20 quad_perm:[2,2,2,2] row_mask:0xf bank_mask:0xf
  v_fmac_f32_dpp v25, v54, v20 quad_perm:[2,2,2,2] row_mask:0xf bank_mask:0xf
  v_fmac_f32_dpp v26, v58, v20 quad_perm:[2,2,2,2] row_mask:0xf bank_mask:0xf
  v_fmac_f32_dpp v27, v62, v20 quad_perm:[2,2,2,2] row_mask:0xf bank_mask:0xf
  v_fmac_f32_dpp v24, v51, v20 quad_perm:[3,3,3,3] row_mask:0xf bank_mask:0xf
  v_fmac_f32_dpp v25, v55, v20 quad_perm:[3,3,3,3] row_mask:0xf bank_mask:0xf
  v_fmac_f32_dpp v26, v59, v20 quad_perm:[3,3,3,3] row_mask:0xf bank_mask:0xf
  v_fmac_f32_dpp v27, v63, v20 quad_perm:[3,3,3,3] row_mask:0xf bank_mask:0xf
  v_max3_f32 v23, v24, v25, v26
  v_max3_f32 v23, v23, v27, v16
  v_mov_b32 v46, v23
  s_nop 1
  v_permlane16_swap_b32 v23, v46
  v_max_f32 v23, v23, v46
  v_mov_b32 v46, v23
  s_nop 1
  v_permlane32_swap_b32 v23, v46
  v_max_f32 v23, v23, v46
  v_sub_f32 v18, v16, v23
  v_sub_f32 v24, v24, v23
  v_sub_f32 v25, v25, v23
  v_sub_f32 v26, v26, v23
  v_sub_f32 v27, v27, v23
  v_exp_f32 v18, v18
  v_exp_f32 v24, v24
  v_exp_f32 v25, v25
  v_exp_f32 v26, v26
  v_exp_f32 v27, v27
  v_mov_b32 v16, v23
  v_pk_mul_f32 v[8:9], v[8:9], v[18:19] op_sel_hi:[1,0]
  v_pk_mul_f32 v[10:11], v[10:11], v[18:19] op_sel_hi:[1,0]
  v_pk_mul_f32 v[12:13], v[12:13], v[18:19] op_sel_hi:[1,0]
  v_pk_mul_f32 v[14:15], v[14:15], v[18:19] op_sel_hi:[1,0]
  v_fma_f32 v17, v17, v18, v24
  v_cvt_pk_bf16_f32 v31, v24, v24
  v_and_b32 v30, v21, v31
  v_and_b32 v31, v22, v31
  v_cvt_pk_bf16_f32 v35, v25, v25
  v_add_f32 v17, v17, v25
  v_and_b32 v34, v21, v35
  v_and_b32 v35, v22, v35
  v_cvt_pk_bf16_f32 v39, v26, v26
  v_add_f32 v17, v17, v26
  v_and_b32 v38, v21, v39
  v_and_b32 v39, v22, v39
  v_cvt_pk_bf16_f32 v43, v27, v27
  v_add_f32 v17, v17, v27
  v_and_b32 v42, v21, v43
  v_and_b32 v43, v22, v43
  s_add_u32 s39, s39, 0x20000
  s_and_b32 s39, s39, 0x1fffff
  s_or_b32 s39, s39, s45
  s_waitcnt vmcnt(5)
  buffer_load_dwordx4 v[64:67], v1, s[8:11], s39 offen offset:0 nt
  v_mfma_f32_16x16x32_bf16 v[8:11], v[144:147], v[30:33], v[8:11]
  v_mfma_f32_16x16x32_bf16 v[12:15], v[144:147], v[28:31], v[12:15]
  v_mfma_f32_16x16x32_bf16 v[8:11], v[148:151], v[34:37], v[8:11]
  v_mfma_f32_16x16x32_bf16 v[12:15], v[148:151], v[32:35], v[12:15]
  v_mfma_f32_16x16x32_bf16 v[8:11], v[152:155], v[38:41], v[8:11]
  v_mfma_f32_16x16x32_bf16 v[12:15], v[152:155], v[36:39], v[12:15]
  v_mfma_f32_16x16x32_bf16 v[8:11], v[156:159], v[42:45], v[8:11]
  v_mfma_f32_16x16x32_bf16 v[12:15], v[156:159], v[40:43], v[12:15]
  s_waitcnt vmcnt(5)
  buffer_load_dwordx4 v[68:71], v1, s[8:11], s39 offen offset:1024 nt
  s_waitcnt vmcnt(5)
  buffer_load_dwordx4 v[72:75], v1, s[8:11], s39 offen offset:2048 nt
  v_mov_b32 v63, 1
  ds_write_b32 v28, v63 offset:42560
  v_mfma_f32_16x16x32_bf16 v[48:51], v[160:163], v[4:7], 0
  v_mfma_f32_16x16x32_bf16 v[52:55], v[164:167], v[4:7], 0
  v_mfma_f32_16x16x32_bf16 v[56:59], v[168:171], v[4:7], 0
  v_mfma_f32_16x16x32_bf16 v[60:63], v[172:175], v[4:7], 0
  s_nop 4
  v_mul_f32_dpp v24, v48, v20 quad_perm:[0,0,0,0] row_mask:0xf bank_mask:0xf
  v_mul_f32_dpp v25, v52, v20 quad_perm:[0,0,0,0] row_mask:0xf bank_mask:0xf
  v_mul_f32_dpp v26, v56, v20 quad_perm:[0,0,0,0] row_mask:0xf bank_mask:0xf
  v_mul_f32_dpp v27, v60, v20 quad_perm:[0,0,0,0] row_mask:0xf bank_mask:0xf
  v_fmac_f32_dpp v24, v49, v20 quad_perm:[1,1,1,1] row_mask:0xf bank_mask:0xf
  v_fmac_f32_dpp v25, v53, v20 quad_perm:[1,1,1,1] row_mask:0xf bank_mask:0xf
  v_fmac_f32_dpp v26, v57, v20 quad_perm:[1,1,1,1] row_mask:0xf bank_mask:0xf
  v_fmac_f32_dpp v27, v61, v20 quad_perm:[1,1,1,1] row_mask:0xf bank_mask:0xf
  v_fmac_f32_dpp v24, v50, v20 quad_perm:[2,2,2,2] row_mask:0xf bank_mask:0xf
  v_fmac_f32_dpp v25, v54, v20 quad_perm:[2,2,2,2] row_mask:0xf bank_mask:0xf
  v_fmac_f32_dpp v26, v58, v20 quad_perm:[2,2,2,2] row_mask:0xf bank_mask:0xf
  v_fmac_f32_dpp v27, v62, v20 quad_perm:[2,2,2,2] row_mask:0xf bank_mask:0xf
  v_fmac_f32_dpp v24, v51, v20 quad_perm:[3,3,3,3] row_mask:0xf bank_mask:0xf
  v_fmac_f32_dpp v25, v55, v20 quad_perm:[3,3,3,3] row_mask:0xf bank_mask:0xf
  v_fmac_f32_dpp v26, v59, v20 quad_perm:[3,3,3,3] row_mask:0xf bank_mask:0xf
  v_fmac_f32_dpp v27, v63, v20 quad_perm:[3,3,3,3] row_mask:0xf bank_mask:0xf
  v_max3_f32 v23, v24, v25, v26
  v_max3_f32 v23, v23, v27, v16
  v_mov_b32 v46, v23
  s_nop 1
  v_permlane16_swap_b32 v23, v46
  v_max_f32 v23, v23, v46
  v_mov_b32 v46, v23
  s_nop 1
  v_permlane32_swap_b32 v23, v46
  v_max_f32 v23, v23, v46
  v_sub_f32 v18, v16, v23
  v_sub_f32 v24, v24, v23
  v_sub_f32 v25, v25, v23
  v_sub_f32 v26, v26, v23
  v_sub_f32 v27, v27, v23
  v_exp_f32 v18, v18
  v_exp_f32 v24, v24
  v_exp_f32 v25, v25
  v_exp_f32 v26, v26
  v_exp_f32 v27, v27
  v_mov_b32 v16, v23
  v_pk_mul_f32 v[8:9], v[8:9], v[18:19] op_sel_hi:[1,0]
  v_pk_mul_f32 v[10:11], v[10:11], v[18:19] op_sel_hi:[1,0]
  v_pk_mul_f32 v[12:13], v[12:13], v[18:19] op_sel_hi:[1,0]
  v_pk_mul_f32 v[14:15], v[14:15], v[18:19] op_sel_hi:[1,0]
  v_fma_f32 v17, v17, v18, v24
  v_cvt_pk_bf16_f32 v31, v24, v24
  v_and_b32 v30, v21, v31
  v_and_b32 v31, v22, v31
  v_cvt_pk_bf16_f32 v35, v25, v25
  v_add_f32 v17, v17, v25
  v_and_b32 v34, v21, v35
  v_and_b32 v35, v22, v35
  v_cvt_pk_bf16_f32 v39, v26, v26
  v_add_f32 v17, v17, v26
  v_and_b32 v38, v21, v39
  v_and_b32 v39, v22, v39
  v_cvt_pk_bf16_f32 v43, v27, v27
  v_add_f32 v17, v17, v27
  v_and_b32 v42, v21, v43
  v_and_b32 v43, v22, v43
  s_waitcnt vmcnt(5)
  buffer_load_dwordx4 v[76:79], v1, s[8:11], s39 offen offset:3072 nt
  v_mfma_f32_16x16x32_bf16 v[8:11], v[176:179], v[30:33], v[8:11]
  v_mfma_f32_16x16x32_bf16 v[12:15], v[176:179], v[28:31], v[12:15]
  v_mfma_f32_16x16x32_bf16 v[8:11], v[180:183], v[34:37], v[8:11]
  v_mfma_f32_16x16x32_bf16 v[12:15], v[180:183], v[32:35], v[12:15]
  v_mfma_f32_16x16x32_bf16 v[8:11], v[184:187], v[38:41], v[8:11]
  v_mfma_f32_16x16x32_bf16 v[12:15], v[184:187], v[36:39], v[12:15]
  v_mfma_f32_16x16x32_bf16 v[8:11], v[188:191], v[42:45], v[8:11]
  v_mfma_f32_16x16x32_bf16 v[12:15], v[188:191], v[40:43], v[12:15]
  s_waitcnt vmcnt(5)
  buffer_load_dwordx4 v[80:83], v2, s[12:15], s39 offen offset:0 nt
  s_waitcnt vmcnt(5)
  buffer_load_dwordx4 v[84:87], v2, s[12:15], s39 offen offset:1024 nt
  v_mfma_f32_16x16x32_bf16 v[48:51], v[192:195], v[4:7], 0
  v_mfma_f32_16x16x32_bf16 v[52:55], v[196:199], v[4:7], 0
  v_mfma_f32_16x16x32_bf16 v[56:59], v[200:203], v[4:7], 0
  v_mfma_f32_16x16x32_bf16 v[60:63], v[204:207], v[4:7], 0
  s_nop 4
  v_mul_f32_dpp v24, v48, v20 quad_perm:[0,0,0,0] row_mask:0xf bank_mask:0xf
  v_mul_f32_dpp v25, v52, v20 quad_perm:[0,0,0,0] row_mask:0xf bank_mask:0xf
  v_mul_f32_dpp v26, v56, v20 quad_perm:[0,0,0,0] row_mask:0xf bank_mask:0xf
  v_mul_f32_dpp v27, v60, v20 quad_perm:[0,0,0,0] row_mask:0xf bank_mask:0xf
  v_fmac_f32_dpp v24, v49, v20 quad_perm:[1,1,1,1] row_mask:0xf bank_mask:0xf
  v_fmac_f32_dpp v25, v53, v20 quad_perm:[1,1,1,1] row_mask:0xf bank_mask:0xf
  v_fmac_f32_dpp v26, v57, v20 quad_perm:[1,1,1,1] row_mask:0xf bank_mask:0xf
  v_fmac_f32_dpp v27, v61, v20 quad_perm:[1,1,1,1] row_mask:0xf bank_mask:0xf
  v_fmac_f32_dpp v24, v50, v20 quad_perm:[2,2,2,2] row_mask:0xf bank_mask:0xf
  v_fmac_f32_dpp v25, v54, v20 quad_perm:[2,2,2,2] row_mask:0xf bank_mask:0xf
  v_fmac_f32_dpp v26, v58, v20 quad_perm:[2,2,2,2] row_mask:0xf bank_mask:0xf
  v_fmac_f32_dpp v27, v62, v20 quad_perm:[2,2,2,2] row_mask:0xf bank_mask:0xf
  v_fmac_f32_dpp v24, v51, v20 quad_perm:[3,3,3,3] row_mask:0xf bank_mask:0xf
  v_fmac_f32_dpp v25, v55, v20 quad_perm:[3,3,3,3] row_mask:0xf bank_mask:0xf
  v_fmac_f32_dpp v26, v59, v20 quad_perm:[3,3,3,3] row_mask:0xf bank_mask:0xf
  v_fmac_f32_dpp v27, v63, v20 quad_perm:[3,3,3,3] row_mask:0xf bank_mask:0xf
  v_max3_f32 v23, v24, v25, v26
  v_max3_f32 v23, v23, v27, v16
  v_mov_b32 v46, v23
  s_nop 1
  v_permlane16_swap_b32 v23, v46
  v_max_f32 v23, v23, v46
  v_mov_b32 v46, v23
  s_nop 1
  v_permlane32_swap_b32 v23, v46
  v_max_f32 v23, v23, v46
  v_sub_f32 v18, v16, v23
  v_sub_f32 v24, v24, v23
  v_sub_f32 v25, v25, v23
  v_sub_f32 v26, v26, v23
  v_sub_f32 v27, v27, v23
  v_exp_f32 v18, v18
  v_exp_f32 v24, v24
  v_exp_f32 v25, v25
  v_exp_f32 v26, v26
  v_exp_f32 v27, v27
  v_mov_b32 v16, v23
  v_pk_mul_f32 v[8:9], v[8:9], v[18:19] op_sel_hi:[1,0]
  v_pk_mul_f32 v[10:11], v[10:11], v[18:19] op_sel_hi:[1,0]
  v_pk_mul_f32 v[12:13], v[12:13], v[18:19] op_sel_hi:[1,0]
  v_pk_mul_f32 v[14:15], v[14:15], v[18:19] op_sel_hi:[1,0]
  v_fma_f32 v17, v17, v18, v24
  v_cvt_pk_bf16_f32 v31, v24, v24
  v_and_b32 v30, v21, v31
  v_and_b32 v31, v22, v31
  v_cvt_pk_bf16_f32 v35, v25, v25
  v_add_f32 v17, v17, v25
  v_and_b32 v34, v21, v35
  v_and_b32 v35, v22, v35
  v_cvt_pk_bf16_f32 v39, v26, v26
  v_add_f32 v17, v17, v26
  v_and_b32 v38, v21, v39
  v_and_b32 v39, v22, v39
  v_cvt_pk_bf16_f32 v43, v27, v27
  v_add_f32 v17, v17, v27
  v_and_b32 v42, v21, v43
  v_and_b32 v43, v22, v43
  s_waitcnt vmcnt(5)
  buffer_load_dwordx4 v[88:91], v2, s[12:15], s39 offen offset:2048 nt
  v_mfma_f32_16x16x32_bf16 v[8:11], v[208:211], v[30:33], v[8:11]
  v_mfma_f32_16x16x32_bf16 v[12:15], v[208:211], v[28:31], v[12:15]
  v_mfma_f32_16x16x32_bf16 v[8:11], v[212:215], v[34:37], v[8:11]
  v_mfma_f32_16x16x32_bf16 v[12:15], v[212:215], v[32:35], v[12:15]
  v_mfma_f32_16x16x32_bf16 v[8:11], v[216:219], v[38:41], v[8:11]
  v_mfma_f32_16x16x32_bf16 v[12:15], v[216:219], v[36:39], v[12:15]
  v_mfma_f32_16x16x32_bf16 v[8:11], v[220:223], v[42:45], v[8:11]
  v_mfma_f32_16x16x32_bf16 v[12:15], v[220:223], v[40:43], v[12:15]
  s_waitcnt vmcnt(5)
  buffer_load_dwordx4 v[92:95], v2, s[12:15], s39 offen offset:3072 nt
  s_add_u32 s39, s39, 0x20000
  s_and_b32 s39, s39, 0x1fffff
  s_or_b32 s39, s39, s45
  s_waitcnt vmcnt(5)
  buffer_load_dwordx4 v[96:99], v1, s[8:11], s39 offen offset:0 nt
  v_mfma_f32_16x16x32_bf16 v[48:51], v[224:227], v[4:7], 0
  v_mfma_f32_16x16x32_bf16 v[52:55], v[228:231], v[4:7], 0
  v_mfma_f32_16x16x32_bf16 v[56:59], v[232:235], v[4:7], 0
  v_mfma_f32_16x16x32_bf16 v[60:63], v[236:239], v[4:7], 0
  s_nop 4
  v_mul_f32_dpp v24, v48, v20 quad_perm:[0,0,0,0] row_mask:0xf bank_mask:0xf
  v_mul_f32_dpp v25, v52, v20 quad_perm:[0,0,0,0] row_mask:0xf bank_mask:0xf
  v_mul_f32_dpp v26, v56, v20 quad_perm:[0,0,0,0] row_mask:0xf bank_mask:0xf
  v_mul_f32_dpp v27, v60, v20 quad_perm:[0,0,0,0] row_mask:0xf bank_mask:0xf
  v_fmac_f32_dpp v24, v49, v20 quad_perm:[1,1,1,1] row_mask:0xf bank_mask:0xf
  v_fmac_f32_dpp v25, v53, v20 quad_perm:[1,1,1,1] row_mask:0xf bank_mask:0xf
  v_fmac_f32_dpp v26, v57, v20 quad_perm:[1,1,1,1] row_mask:0xf bank_mask:0xf
  v_fmac_f32_dpp v27, v61, v20 quad_perm:[1,1,1,1] row_mask:0xf bank_mask:0xf
  v_fmac_f32_dpp v24, v50, v20 quad_perm:[2,2,2,2] row_mask:0xf bank_mask:0xf
  v_fmac_f32_dpp v25, v54, v20 quad_perm:[2,2,2,2] row_mask:0xf bank_mask:0xf
  v_fmac_f32_dpp v26, v58, v20 quad_perm:[2,2,2,2] row_mask:0xf bank_mask:0xf
  v_fmac_f32_dpp v27, v62, v20 quad_perm:[2,2,2,2] row_mask:0xf bank_mask:0xf
  v_fmac_f32_dpp v24, v51, v20 quad_perm:[3,3,3,3] row_mask:0xf bank_mask:0xf
  v_fmac_f32_dpp v25, v55, v20 quad_perm:[3,3,3,3] row_mask:0xf bank_mask:0xf
  v_fmac_f32_dpp v26, v59, v20 quad_perm:[3,3,3,3] row_mask:0xf bank_mask:0xf
  v_fmac_f32_dpp v27, v63, v20 quad_perm:[3,3,3,3] row_mask:0xf bank_mask:0xf
  v_max3_f32 v23, v24, v25, v26
  v_max3_f32 v23, v23, v27, v16
  v_mov_b32 v46, v23
  s_nop 1
  v_permlane16_swap_b32 v23, v46
  v_max_f32 v23, v23, v46
  v_mov_b32 v46, v23
  s_nop 1
  v_permlane32_swap_b32 v23, v46
  v_max_f32 v23, v23, v46
  v_sub_f32 v18, v16, v23
  v_sub_f32 v24, v24, v23
  v_sub_f32 v25, v25, v23
  v_sub_f32 v26, v26, v23
  v_sub_f32 v27, v27, v23
  v_exp_f32 v18, v18
  v_exp_f32 v24, v24
  v_exp_f32 v25, v25
  v_exp_f32 v26, v26
  v_exp_f32 v27, v27
  v_mov_b32 v16, v23
  v_pk_mul_f32 v[8:9], v[8:9], v[18:19] op_sel_hi:[1,0]
  v_pk_mul_f32 v[10:11], v[10:11], v[18:19] op_sel_hi:[1,0]
  v_pk_mul_f32 v[12:13], v[12:13], v[18:19] op_sel_hi:[1,0]
  v_pk_mul_f32 v[14:15], v[14:15], v[18:19] op_sel_hi:[1,0]
  v_fma_f32 v17, v17, v18, v24
  v_cvt_pk_bf16_f32 v31, v24, v24
  v_and_b32 v30, v21, v31
  v_and_b32 v31, v22, v31
  v_cvt_pk_bf16_f32 v35, v25, v25
  v_add_f32 v17, v17, v25
  v_and_b32 v34, v21, v35
  v_and_b32 v35, v22, v35
  v_cvt_pk_bf16_f32 v39, v26, v26
  v_add_f32 v17, v17, v26
  v_and_b32 v38, v21, v39
  v_and_b32 v39, v22, v39
  v_cvt_pk_bf16_f32 v43, v27, v27
  v_add_f32 v17, v17, v27
  v_and_b32 v42, v21, v43
  v_and_b32 v43, v22, v43
  s_waitcnt vmcnt(5)
  buffer_load_dwordx4 v[100:103], v1, s[8:11], s39 offen offset:1024 nt
  v_mfma_f32_16x16x32_bf16 v[8:11], v[240:243], v[30:33], v[8:11]
  v_mfma_f32_16x16x32_bf16 v[12:15], v[240:243], v[28:31], v[12:15]
  v_mfma_f32_16x16x32_bf16 v[8:11], v[244:247], v[34:37], v[8:11]
  v_mfma_f32_16x16x32_bf16 v[12:15], v[244:247], v[32:35], v[12:15]
  v_mfma_f32_16x16x32_bf16 v[8:11], v[248:251], v[38:41], v[8:11]
  v_mfma_f32_16x16x32_bf16 v[12:15], v[248:251], v[36:39], v[12:15]
  v_mfma_f32_16x16x32_bf16 v[8:11], v[252:255], v[42:45], v[8:11]
  v_mfma_f32_16x16x32_bf16 v[12:15], v[252:255], v[40:43], v[12:15]
  s_waitcnt vmcnt(5)
  buffer_load_dwordx4 v[104:107], v1, s[8:11], s39 offen offset:2048 nt
  s_waitcnt vmcnt(5)
  buffer_load_dwordx4 v[108:111], v1, s[8:11], s39 offen offset:3072 nt
  v_mfma_f32_16x16x32_bf16 v[48:51], v[64:67], v[4:7], 0
  v_mfma_f32_16x16x32_bf16 v[52:55], v[68:71], v[4:7], 0
  v_mfma_f32_16x16x32_bf16 v[56:59], v[72:75], v[4:7], 0
  v_mfma_f32_16x16x32_bf16 v[60:63], v[76:79], v[4:7], 0
  s_nop 4
  v_mul_f32_dpp v24, v48, v20 quad_perm:[0,0,0,0] row_mask:0xf bank_mask:0xf
  v_mul_f32_dpp v25, v52, v20 quad_perm:[0,0,0,0] row_mask:0xf bank_mask:0xf
  v_mul_f32_dpp v26, v56, v20 quad_perm:[0,0,0,0] row_mask:0xf bank_mask:0xf
  v_mul_f32_dpp v27, v60, v20 quad_perm:[0,0,0,0] row_mask:0xf bank_mask:0xf
  v_fmac_f32_dpp v24, v49, v20 quad_perm:[1,1,1,1] row_mask:0xf bank_mask:0xf
  v_fmac_f32_dpp v25, v53, v20 quad_perm:[1,1,1,1] row_mask:0xf bank_mask:0xf
  v_fmac_f32_dpp v26, v57, v20 quad_perm:[1,1,1,1] row_mask:0xf bank_mask:0xf
  v_fmac_f32_dpp v27, v61, v20 quad_perm:[1,1,1,1] row_mask:0xf bank_mask:0xf
  v_fmac_f32_dpp v24, v50, v20 quad_perm:[2,2,2,2] row_mask:0xf bank_mask:0xf
  v_fmac_f32_dpp v25, v54, v20 quad_perm:[2,2,2,2] row_mask:0xf bank_mask:0xf
  v_fmac_f32_dpp v26, v58, v20 quad_perm:[2,2,2,2] row_mask:0xf bank_mask:0xf
  v_fmac_f32_dpp v27, v62, v20 quad_perm:[2,2,2,2] row_mask:0xf bank_mask:0xf
  v_fmac_f32_dpp v24, v51, v20 quad_perm:[3,3,3,3] row_mask:0xf bank_mask:0xf
  v_fmac_f32_dpp v25, v55, v20 quad_perm:[3,3,3,3] row_mask:0xf bank_mask:0xf
  v_fmac_f32_dpp v26, v59, v20 quad_perm:[3,3,3,3] row_mask:0xf bank_mask:0xf
  v_fmac_f32_dpp v27, v63, v20 quad_perm:[3,3,3,3] row_mask:0xf bank_mask:0xf
  v_max3_f32 v23, v24, v25, v26
  v_max3_f32 v23, v23, v27, v16
  v_mov_b32 v46, v23
  s_nop 1
  v_permlane16_swap_b32 v23, v46
  v_max_f32 v23, v23, v46
  v_mov_b32 v46, v23
  s_nop 1
  v_permlane32_swap_b32 v23, v46
  v_max_f32 v23, v23, v46
  v_sub_f32 v18, v16, v23
  v_sub_f32 v24, v24, v23
  v_sub_f32 v25, v25, v23
  v_sub_f32 v26, v26, v23
  v_sub_f32 v27, v27, v23
  v_exp_f32 v18, v18
  v_exp_f32 v24, v24
  v_exp_f32 v25, v25
  v_exp_f32 v26, v26
  v_exp_f32 v27, v27
  v_mov_b32 v16, v23
  v_pk_mul_f32 v[8:9], v[8:9], v[18:19] op_sel_hi:[1,0]
  v_pk_mul_f32 v[10:11], v[10:11], v[18:19] op_sel_hi:[1,0]
  v_pk_mul_f32 v[12:13], v[12:13], v[18:19] op_sel_hi:[1,0]
  v_pk_mul_f32 v[14:15], v[14:15], v[18:19] op_sel_hi:[1,0]
  v_fma_f32 v17, v17, v18, v24
  v_cvt_pk_bf16_f32 v31, v24, v24
  v_and_b32 v30, v21, v31
  v_and_b32 v31, v22, v31
  v_cvt_pk_bf16_f32 v35, v25, v25
  v_add_f32 v17, v17, v25
  v_and_b32 v34, v21, v35
  v_and_b32 v35, v22, v35
  v_cvt_pk_bf16_f32 v39, v26, v26
  v_add_f32 v17, v17, v26
  v_and_b32 v38, v21, v39
  v_and_b32 v39, v22, v39
  v_cvt_pk_bf16_f32 v43, v27, v27
  v_add_f32 v17, v17, v27
  v_and_b32 v42, v21, v43
  v_and_b32 v43, v22, v43
  s_waitcnt vmcnt(5)
  buffer_load_dwordx4 v[112:115], v2, s[12:15], s39 offen offset:0 nt
  s_waitcnt vmcnt(5)
  buffer_load_dwordx4 v[116:119], v2, s[12:15], s39 offen offset:1024 nt
  v_mfma_f32_16x16x32_bf16 v[8:11], v[80:83], v[30:33], v[8:11]
  v_mfma_f32_16x16x32_bf16 v[12:15], v[80:83], v[28:31], v[12:15]
  v_mfma_f32_16x16x32_bf16 v[8:11], v[84:87], v[34:37], v[8:11]
  v_mfma_f32_16x16x32_bf16 v[12:15], v[84:87], v[32:35], v[12:15]
  v_mfma_f32_16x16x32_bf16 v[8:11], v[88:91], v[38:41], v[8:11]
  v_mfma_f32_16x16x32_bf16 v[12:15], v[88:91], v[36:39], v[12:15]
  v_mfma_f32_16x16x32_bf16 v[8:11], v[92:95], v[42:45], v[8:11]
  v_mfma_f32_16x16x32_bf16 v[12:15], v[92:95], v[40:43], v[12:15]
  s_waitcnt vmcnt(5)
  buffer_load_dwordx4 v[120:123], v2, s[12:15], s39 offen offset:2048 nt
  s_waitcnt vmcnt(5)
  buffer_load_dwordx4 v[124:127], v2, s[12:15], s39 offen offset:3072 nt
  s_add_u32 s39, s39, 0x20000
  s_and_b32 s39, s39, 0x1fffff
  s_or_b32 s39, s39, s45
  s_waitcnt vmcnt(5)
  buffer_load_dwordx4 v[128:131], v1, s[8:11], s39 offen offset:0 nt
  s_waitcnt vmcnt(5)
  buffer_load_dwordx4 v[132:135], v1, s[8:11], s39 offen offset:1024 nt
  v_mfma_f32_16x16x32_bf16 v[48:51], v[96:99], v[4:7], 0
  v_mfma_f32_16x16x32_bf16 v[52:55], v[100:103], v[4:7], 0
  v_mfma_f32_16x16x32_bf16 v[56:59], v[104:107], v[4:7], 0
  v_mfma_f32_16x16x32_bf16 v[60:63], v[108:111], v[4:7], 0
  s_nop 4
  v_mul_f32_dpp v24, v48, v20 quad_perm:[0,0,0,0] row_mask:0xf bank_mask:0xf
  v_mul_f32_dpp v25, v52, v20 quad_perm:[0,0,0,0] row_mask:0xf bank_mask:0xf
  v_mul_f32_dpp v26, v56, v20 quad_perm:[0,0,0,0] row_mask:0xf bank_mask:0xf
  v_mul_f32_dpp v27, v60, v20 quad_perm:[0,0,0,0] row_mask:0xf bank_mask:0xf
  v_fmac_f32_dpp v24, v49, v20 quad_perm:[1,1,1,1] row_mask:0xf bank_mask:0xf
  v_fmac_f32_dpp v25, v53, v20 quad_perm:[1,1,1,1] row_mask:0xf bank_mask:0xf
  v_fmac_f32_dpp v26, v57, v20 quad_perm:[1,1,1,1] row_mask:0xf bank_mask:0xf
  v_fmac_f32_dpp v27, v61, v20 quad_perm:[1,1,1,1] row_mask:0xf bank_mask:0xf
  v_fmac_f32_dpp v24, v50, v20 quad_perm:[2,2,2,2] row_mask:0xf bank_mask:0xf
  v_fmac_f32_dpp v25, v54, v20 quad_perm:[2,2,2,2] row_mask:0xf bank_mask:0xf
  v_fmac_f32_dpp v26, v58, v20 quad_perm:[2,2,2,2] row_mask:0xf bank_mask:0xf
  v_fmac_f32_dpp v27, v62, v20 quad_perm:[2,2,2,2] row_mask:0xf bank_mask:0xf
  v_fmac_f32_dpp v24, v51, v20 quad_perm:[3,3,3,3] row_mask:0xf bank_mask:0xf
  v_fmac_f32_dpp v25, v55, v20 quad_perm:[3,3,3,3] row_mask:0xf bank_mask:0xf
  v_fmac_f32_dpp v26, v59, v20 quad_perm:[3,3,3,3] row_mask:0xf bank_mask:0xf
  v_fmac_f32_dpp v27, v63, v20 quad_perm:[3,3,3,3] row_mask:0xf bank_mask:0xf
  v_max3_f32 v23, v24, v25, v26
  v_max3_f32 v23, v23, v27, v16
  v_mov_b32 v46, v23
  s_nop 1
  v_permlane16_swap_b32 v23, v46
  v_max_f32 v23, v23, v46
  v_mov_b32 v46, v23
  s_nop 1
  v_permlane32_swap_b32 v23, v46
  v_max_f32 v23, v23, v46
  v_sub_f32 v18, v16, v23
  v_sub_f32 v24, v24, v23
  v_sub_f32 v25, v25, v23
  v_sub_f32 v26, v26, v23
  v_sub_f32 v27, v27, v23
  v_exp_f32 v18, v18
  v_exp_f32 v24, v24
  v_exp_f32 v25, v25
  v_exp_f32 v26, v26
  v_exp_f32 v27, v27
  v_mov_b32 v16, v23
  v_pk_mul_f32 v[8:9], v[8:9], v[18:19] op_sel_hi:[1,0]
  v_pk_mul_f32 v[10:11], v[10:11], v[18:19] op_sel_hi:[1,0]
  v_pk_mul_f32 v[12:13], v[12:13], v[18:19] op_sel_hi:[1,0]
  v_pk_mul_f32 v[14:15], v[14:15], v[18:19] op_sel_hi:[1,0]
  v_fma_f32 v17, v17, v18, v24
  v_cvt_pk_bf16_f32 v31, v24, v24
  v_and_b32 v30, v21, v31
  v_and_b32 v31, v22, v31
  v_cvt_pk_bf16_f32 v35, v25, v25
  v_add_f32 v17, v17, v25
  v_and_b32 v34, v21, v35
  v_and_b32 v35, v22, v35
  v_cvt_pk_bf16_f32 v39, v26, v26
  v_add_f32 v17, v17, v26
  v_and_b32 v38, v21, v39
  v_and_b32 v39, v22, v39
  v_cvt_pk_bf16_f32 v43, v27, v27
  v_add_f32 v17, v17, v27
  v_and_b32 v42, v21, v43
  v_and_b32 v43, v22, v43
  s_waitcnt vmcnt(5)
  buffer_load_dwordx4 v[136:139], v1, s[8:11], s39 offen offset:2048 nt
  s_waitcnt vmcnt(5)
  buffer_load_dwordx4 v[140:143], v1, s[8:11], s39 offen offset:3072 nt
  s_waitcnt vmcnt(5)
  buffer_load_dwordx4 v[144:147], v2, s[12:15], s39 offen offset:0 nt
  s_waitcnt vmcnt(5)
  buffer_load_dwordx4 v[148:151], v2, s[12:15], s39 offen offset:1024 nt
  v_mfma_f32_16x16x32_bf16 v[8:11], v[112:115], v[30:33], v[8:11]
  v_mfma_f32_16x16x32_bf16 v[12:15], v[112:115], v[28:31], v[12:15]
  v_mfma_f32_16x16x32_bf16 v[8:11], v[116:119], v[34:37], v[8:11]
  v_mfma_f32_16x16x32_bf16 v[12:15], v[116:119], v[32:35], v[12:15]
  v_mfma_f32_16x16x32_bf16 v[8:11], v[120:123], v[38:41], v[8:11]
  v_mfma_f32_16x16x32_bf16 v[12:15], v[120:123], v[36:39], v[12:15]
  v_mfma_f32_16x16x32_bf16 v[8:11], v[124:127], v[42:45], v[8:11]
  v_mfma_f32_16x16x32_bf16 v[12:15], v[124:127], v[40:43], v[12:15]
  s_waitcnt vmcnt(5)
  buffer_load_dwordx4 v[152:155], v2, s[12:15], s39 offen offset:2048 nt
  s_waitcnt vmcnt(5)
  buffer_load_dwordx4 v[156:159], v2, s[12:15], s39 offen offset:3072 nt
  s_add_u32 s39, s39, 0x20000
  s_and_b32 s39, s39, 0x1fffff
  s_or_b32 s39, s39, s45
  s_waitcnt vmcnt(5)
  buffer_load_dwordx4 v[160:163], v1, s[8:11], s39 offen offset:0 nt
  s_waitcnt vmcnt(5)
  buffer_load_dwordx4 v[164:167], v1, s[8:11], s39 offen offset:1024 nt
  v_mfma_f32_16x16x32_bf16 v[48:51], v[128:131], v[4:7], 0
  v_mfma_f32_16x16x32_bf16 v[52:55], v[132:135], v[4:7], 0
  v_mfma_f32_16x16x32_bf16 v[56:59], v[136:139], v[4:7], 0
  v_mfma_f32_16x16x32_bf16 v[60:63], v[140:143], v[4:7], 0
  s_nop 4
  v_mul_f32_dpp v24, v48, v20 quad_perm:[0,0,0,0] row_mask:0xf bank_mask:0xf
  v_mul_f32_dpp v25, v52, v20 quad_perm:[0,0,0,0] row_mask:0xf bank_mask:0xf
  v_mul_f32_dpp v26, v56, v20 quad_perm:[0,0,0,0] row_mask:0xf bank_mask:0xf
  v_mul_f32_dpp v27, v60, v20 quad_perm:[0,0,0,0] row_mask:0xf bank_mask:0xf
  v_fmac_f32_dpp v24, v49, v20 quad_perm:[1,1,1,1] row_mask:0xf bank_mask:0xf
  v_fmac_f32_dpp v25, v53, v20 quad_perm:[1,1,1,1] row_mask:0xf bank_mask:0xf
  v_fmac_f32_dpp v26, v57, v20 quad_perm:[1,1,1,1] row_mask:0xf bank_mask:0xf
  v_fmac_f32_dpp v27, v61, v20 quad_perm:[1,1,1,1] row_mask:0xf bank_mask:0xf
  v_fmac_f32_dpp v24, v50, v20 quad_perm:[2,2,2,2] row_mask:0xf bank_mask:0xf
  v_fmac_f32_dpp v25, v54, v20 quad_perm:[2,2,2,2] row_mask:0xf bank_mask:0xf
  v_fmac_f32_dpp v26, v58, v20 quad_perm:[2,2,2,2] row_mask:0xf bank_mask:0xf
  v_fmac_f32_dpp v27, v62, v20 quad_perm:[2,2,2,2] row_mask:0xf bank_mask:0xf
  v_fmac_f32_dpp v24, v51, v20 quad_perm:[3,3,3,3] row_mask:0xf bank_mask:0xf
  v_fmac_f32_dpp v25, v55, v20 quad_perm:[3,3,3,3] row_mask:0xf bank_mask:0xf
  v_fmac_f32_dpp v26, v59, v20 quad_perm:[3,3,3,3] row_mask:0xf bank_mask:0xf
  v_fmac_f32_dpp v27, v63, v20 quad_perm:[3,3,3,3] row_mask:0xf bank_mask:0xf
  v_max3_f32 v23, v24, v25, v26
  v_max3_f32 v23, v23, v27, v16
  v_mov_b32 v46, v23
  s_nop 1
  v_permlane16_swap_b32 v23, v46
  v_max_f32 v23, v23, v46
  v_mov_b32 v46, v23
  s_nop 1
  v_permlane32_swap_b32 v23, v46
  v_max_f32 v23, v23, v46
  v_sub_f32 v18, v16, v23
  v_sub_f32 v24, v24, v23
  v_sub_f32 v25, v25, v23
  v_sub_f32 v26, v26, v23
  v_sub_f32 v27, v27, v23
  v_exp_f32 v18, v18
  v_exp_f32 v24, v24
  v_exp_f32 v25, v25
  v_exp_f32 v26, v26
  v_exp_f32 v27, v27
  v_mov_b32 v16, v23
  v_pk_mul_f32 v[8:9], v[8:9], v[18:19] op_sel_hi:[1,0]
  v_pk_mul_f32 v[10:11], v[10:11], v[18:19] op_sel_hi:[1,0]
  v_pk_mul_f32 v[12:13], v[12:13], v[18:19] op_sel_hi:[1,0]
  v_pk_mul_f32 v[14:15], v[14:15], v[18:19] op_sel_hi:[1,0]
  v_fma_f32 v17, v17, v18, v24
  v_cvt_pk_bf16_f32 v31, v24, v24
  v_and_b32 v30, v21, v31
  v_and_b32 v31, v22, v31
  v_cvt_pk_bf16_f32 v35, v25, v25
  v_add_f32 v17, v17, v25
  v_and_b32 v34, v21, v35
  v_and_b32 v35, v22, v35
  v_cvt_pk_bf16_f32 v39, v26, v26
  v_add_f32 v17, v17, v26
  v_and_b32 v38, v21, v39
  v_and_b32 v39, v22, v39
  v_cvt_pk_bf16_f32 v43, v27, v27
  v_add_f32 v17, v17, v27
  v_and_b32 v42, v21, v43
  v_and_b32 v43, v22, v43
  s_waitcnt vmcnt(5)
  buffer_load_dwordx4 v[168:171], v1, s[8:11], s39 offen offset:2048 nt
  s_waitcnt vmcnt(5)
  buffer_load_dwordx4 v[172:175], v1, s[8:11], s39 offen offset:3072 nt
  s_waitcnt vmcnt(5)
  buffer_load_dwordx4 v[176:179], v2, s[12:15], s39 offen offset:0 nt
  s_waitcnt vmcnt(5)
  buffer_load_dwordx4 v[180:183], v2, s[12:15], s39 offen offset:1024 nt
  v_mfma_f32_16x16x32_bf16 v[8:11], v[144:147], v[30:33], v[8:11]
  v_mfma_f32_16x16x32_bf16 v[12:15], v[144:147], v[28:31], v[12:15]
  v_mfma_f32_16x16x32_bf16 v[8:11], v[148:151], v[34:37], v[8:11]
  v_mfma_f32_16x16x32_bf16 v[12:15], v[148:151], v[32:35], v[12:15]
  v_mfma_f32_16x16x32_bf16 v[8:11], v[152:155], v[38:41], v[8:11]
  v_mfma_f32_16x16x32_bf16 v[12:15], v[152:155], v[36:39], v[12:15]
  v_mfma_f32_16x16x32_bf16 v[8:11], v[156:159], v[42:45], v[8:11]
  v_mfma_f32_16x16x32_bf16 v[12:15], v[156:159], v[40:43], v[12:15]
  s_waitcnt vmcnt(5)
  buffer_load_dwordx4 v[184:187], v2, s[12:15], s39 offen offset:2048 nt
  s_waitcnt vmcnt(5)
  buffer_load_dwordx4 v[188:191], v2, s[12:15], s39 offen offset:3072 nt
  s_add_u32 s39, s39, 0x20000
  s_and_b32 s39, s39, 0x1fffff
  s_or_b32 s39, s39, s45
  s_waitcnt vmcnt(5)
  buffer_load_dwordx4 v[192:195], v1, s[8:11], s39 offen offset:0 nt
  s_waitcnt vmcnt(5)
  buffer_load_dwordx4 v[196:199], v1, s[8:11], s39 offen offset:1024 nt
  s_add_u32 s33, s40, 0
  buffer_load_dwordx4 v[224:227], v3, s[16:19], s33 offen
  s_add_u32 s33, s40, 8192
  buffer_load_dwordx4 v[228:231], v3, s[16:19], s33 offen
  s_add_u32 s33, s40, 16384
  buffer_load_dwordx4 v[232:235], v3, s[16:19], s33 offen
  s_add_u32 s33, s40, 24576
  buffer_load_dwordx4 v[236:239], v3, s[16:19], s33 offen
  v_mfma_f32_16x16x32_bf16 v[48:51], v[160:163], v[4:7], 0
  v_mfma_f32_16x16x32_bf16 v[52:55], v[164:167], v[4:7], 0
  v_mfma_f32_16x16x32_bf16 v[56:59], v[168:171], v[4:7], 0
  v_mfma_f32_16x16x32_bf16 v[60:63], v[172:175], v[4:7], 0
  s_nop 4
  v_mul_f32_dpp v24, v48, v20 quad_perm:[0,0,0,0] row_mask:0xf bank_mask:0xf
  v_mul_f32_dpp v25, v52, v20 quad_perm:[0,0,0,0] row_mask:0xf bank_mask:0xf
  v_mul_f32_dpp v26, v56, v20 quad_perm:[0,0,0,0] row_mask:0xf bank_mask:0xf
  v_mul_f32_dpp v27, v60, v20 quad_perm:[0,0,0,0] row_mask:0xf bank_mask:0xf
  v_fmac_f32_dpp v24, v49, v20 quad_perm:[1,1,1,1] row_mask:0xf bank_mask:0xf
  v_fmac_f32_dpp v25, v53, v20 quad_perm:[1,1,1,1] row_mask:0xf bank_mask:0xf
  v_fmac_f32_dpp v26, v57, v20 quad_perm:[1,1,1,1] row_mask:0xf bank_mask:0xf
  v_fmac_f32_dpp v27, v61, v20 quad_perm:[1,1,1,1] row_mask:0xf bank_mask:0xf
  v_fmac_f32_dpp v24, v50, v20 quad_perm:[2,2,2,2] row_mask:0xf bank_mask:0xf
  v_fmac_f32_dpp v25, v54, v20 quad_perm:[2,2,2,2] row_mask:0xf bank_mask:0xf
  v_fmac_f32_dpp v26, v58, v20 quad_perm:[2,2,2,2] row_mask:0xf bank_mask:0xf
  v_fmac_f32_dpp v27, v62, v20 quad_perm:[2,2,2,2] row_mask:0xf bank_mask:0xf
  v_fmac_f32_dpp v24, v51, v20 quad_perm:[3,3,3,3] row_mask:0xf bank_mask:0xf
  v_fmac_f32_dpp v25, v55, v20 quad_perm:[3,3,3,3] row_mask:0xf bank_mask:0xf
  v_fmac_f32_dpp v26, v59, v20 quad_perm:[3,3,3,3] row_mask:0xf bank_mask:0xf
  v_fmac_f32_dpp v27, v63, v20 quad_perm:[3,3,3,3] row_mask:0xf bank_mask:0xf
  v_max3_f32 v23, v24, v25, v26
  v_max3_f32 v23, v23, v27, v16
  v_mov_b32 v46, v23
  s_nop 1
  v_permlane16_swap_b32 v23, v46
  v_max_f32 v23, v23, v46
  v_mov_b32 v46, v23
  s_nop 1
  v_permlane32_swap_b32 v23, v46
  v_max_f32 v23, v23, v46
  v_sub_f32 v18, v16, v23
  v_sub_f32 v24, v24, v23
  v_sub_f32 v25, v25, v23
  v_sub_f32 v26, v26, v23
  v_sub_f32 v27, v27, v23
  v_exp_f32 v18, v18
  v_exp_f32 v24, v24
  v_exp_f32 v25, v25
  v_exp_f32 v26, v26
  v_exp_f32 v27, v27
  v_mov_b32 v16, v23
  v_pk_mul_f32 v[8:9], v[8:9], v[18:19] op_sel_hi:[1,0]
  v_pk_mul_f32 v[10:11], v[10:11], v[18:19] op_sel_hi:[1,0]
  v_pk_mul_f32 v[12:13], v[12:13], v[18:19] op_sel_hi:[1,0]
  v_pk_mul_f32 v[14:15], v[14:15], v[18:19] op_sel_hi:[1,0]
  v_fma_f32 v17, v17, v18, v24
  v_cvt_pk_bf16_f32 v31, v24, v24
  v_and_b32 v30, v21, v31
  v_and_b32 v31, v22, v31
  v_cvt_pk_bf16_f32 v35, v25, v25
  v_add_f32 v17, v17, v25
  v_and_b32 v34, v21, v35
  v_and_b32 v35, v22, v35
  v_cvt_pk_bf16_f32 v39, v26, v26
  v_add_f32 v17, v17, v26
  v_and_b32 v38, v21, v39
  v_and_b32 v39, v22, v39
  v_cvt_pk_bf16_f32 v43, v27, v27
  v_add_f32 v17, v17, v27
  v_and_b32 v42, v21, v43
  v_and_b32 v43, v22, v43
  s_waitcnt vmcnt(9)
  buffer_load_dwordx4 v[200:203], v1, s[8:11], s39 offen offset:2048 nt
  s_waitcnt vmcnt(9)
  buffer_load_dwordx4 v[204:207], v1, s[8:11], s39 offen offset:3072 nt
  s_waitcnt vmcnt(9)
  buffer_load_dwordx4 v[208:211], v2, s[12:15], s39 offen offset:0 nt
  s_waitcnt vmcnt(9)
  buffer_load_dwordx4 v[212:215], v2, s[12:15], s39 offen offset:1024 nt
  s_add_u32 s33, s40, 4096
  buffer_load_dwordx4 v[240:243], v3, s[16:19], s33 offen
  s_add_u32 s33, s40, 12288
  buffer_load_dwordx4 v[244:247], v3, s[16:19], s33 offen
  s_add_u32 s33, s40, 20480
  buffer_load_dwordx4 v[248:251], v3, s[16:19], s33 offen
  s_add_u32 s33, s40, 28672
  buffer_load_dwordx4 v[252:255], v3, s[16:19], s33 offen
  v_mfma_f32_16x16x32_bf16 v[8:11], v[176:179], v[30:33], v[8:11]
  v_mfma_f32_16x16x32_bf16 v[12:15], v[176:179], v[28:31], v[12:15]
  v_mfma_f32_16x16x32_bf16 v[8:11], v[180:183], v[34:37], v[8:11]
  v_mfma_f32_16x16x32_bf16 v[12:15], v[180:183], v[32:35], v[12:15]
  v_mfma_f32_16x16x32_bf16 v[8:11], v[184:187], v[38:41], v[8:11]
  v_mfma_f32_16x16x32_bf16 v[12:15], v[184:187], v[36:39], v[12:15]
  v_mfma_f32_16x16x32_bf16 v[8:11], v[188:191], v[42:45], v[8:11]
  v_mfma_f32_16x16x32_bf16 v[12:15], v[188:191], v[40:43], v[12:15]
  s_waitcnt vmcnt(13)
  buffer_load_dwordx4 v[216:219], v2, s[12:15], s39 offen offset:2048 nt
  s_waitcnt vmcnt(13)
  buffer_load_dwordx4 v[220:223], v2, s[12:15], s39 offen offset:3072 nt
  s_add_u32 s39, s39, 0x20000
  s_and_b32 s39, s39, 0x1fffff
  s_or_b32 s39, s39, s45
  s_waitcnt vmcnt(9)
  buffer_load_dwordx4 v[64:67], v1, s[8:11], s39 offen offset:0 nt
  s_waitcnt vmcnt(9)
  buffer_load_dwordx4 v[68:71], v1, s[8:11], s39 offen offset:1024 nt
  v_mov_b32 v63, 2
  ds_write_b32 v28, v63 offset:42560
  v_mfma_f32_16x16x32_bf16 v[48:51], v[192:195], v[4:7], 0
  v_mfma_f32_16x16x32_bf16 v[52:55], v[196:199], v[4:7], 0
  v_mfma_f32_16x16x32_bf16 v[56:59], v[200:203], v[4:7], 0
  v_mfma_f32_16x16x32_bf16 v[60:63], v[204:207], v[4:7], 0
  s_nop 4
  v_mul_f32_dpp v24, v48, v20 quad_perm:[0,0,0,0] row_mask:0xf bank_mask:0xf
  v_mul_f32_dpp v25, v52, v20 quad_perm:[0,0,0,0] row_mask:0xf bank_mask:0xf
  v_mul_f32_dpp v26, v56, v20 quad_perm:[0,0,0,0] row_mask:0xf bank_mask:0xf
  v_mul_f32_dpp v27, v60, v20 quad_perm:[0,0,0,0] row_mask:0xf bank_mask:0xf
  v_fmac_f32_dpp v24, v49, v20 quad_perm:[1,1,1,1] row_mask:0xf bank_mask:0xf
  v_fmac_f32_dpp v25, v53, v20 quad_perm:[1,1,1,1] row_mask:0xf bank_mask:0xf
  v_fmac_f32_dpp v26, v57, v20 quad_perm:[1,1,1,1] row_mask:0xf bank_mask:0xf
  v_fmac_f32_dpp v27, v61, v20 quad_perm:[1,1,1,1] row_mask:0xf bank_mask:0xf
  v_fmac_f32_dpp v24, v50, v20 quad_perm:[2,2,2,2] row_mask:0xf bank_mask:0xf
  v_fmac_f32_dpp v25, v54, v20 quad_perm:[2,2,2,2] row_mask:0xf bank_mask:0xf
  v_fmac_f32_dpp v26, v58, v20 quad_perm:[2,2,2,2] row_mask:0xf bank_mask:0xf
  v_fmac_f32_dpp v27, v62, v20 quad_perm:[2,2,2,2] row_mask:0xf bank_mask:0xf
  v_fmac_f32_dpp v24, v51, v20 quad_perm:[3,3,3,3] row_mask:0xf bank_mask:0xf
  v_fmac_f32_dpp v25, v55, v20 quad_perm:[3,3,3,3] row_mask:0xf bank_mask:0xf
  v_fmac_f32_dpp v26, v59, v20 quad_perm:[3,3,3,3] row_mask:0xf bank_mask:0xf
  v_fmac_f32_dpp v27, v63, v20 quad_perm:[3,3,3,3] row_mask:0xf bank_mask:0xf
  v_max3_f32 v23, v24, v25, v26
  v_max3_f32 v23, v23, v27, v16
  v_mov_b32 v46, v23
  s_nop 1
  v_permlane16_swap_b32 v23, v46
  v_max_f32 v23, v23, v46
  v_mov_b32 v46, v23
  s_nop 1
  v_permlane32_swap_b32 v23, v46
  v_max_f32 v23, v23, v46
  v_sub_f32 v18, v16, v23
  v_sub_f32 v24, v24, v23
  v_sub_f32 v25, v25, v23
  v_sub_f32 v26, v26, v23
  v_sub_f32 v27, v27, v23
  v_exp_f32 v18, v18
  v_exp_f32 v24, v24
  v_exp_f32 v25, v25
  v_exp_f32 v26, v26
  v_exp_f32 v27, v27
  v_mov_b32 v16, v23
  v_pk_mul_f32 v[8:9], v[8:9], v[18:19] op_sel_hi:[1,0]
  v_pk_mul_f32 v[10:11], v[10:11], v[18:19] op_sel_hi:[1,0]
  v_pk_mul_f32 v[12:13], v[12:13], v[18:19] op_sel_hi:[1,0]
  v_pk_mul_f32 v[14:15], v[14:15], v[18:19] op_sel_hi:[1,0]
  v_fma_f32 v17, v17, v18, v24
  v_cvt_pk_bf16_f32 v31, v24, v24
  v_and_b32 v30, v21, v31
  v_and_b32 v31, v22, v31
  v_cvt_pk_bf16_f32 v35, v25, v25
  v_add_f32 v17, v17, v25
  v_and_b32 v34, v21, v35
  v_and_b32 v35, v22, v35
  v_cvt_pk_bf16_f32 v39, v26, v26
  v_add_f32 v17, v17, v26
  v_and_b32 v38, v21, v39
  v_and_b32 v39, v22, v39
  v_cvt_pk_bf16_f32 v43, v27, v27
  v_add_f32 v17, v17, v27
  v_and_b32 v42, v21, v43
  v_and_b32 v43, v22, v43
  s_waitcnt vmcnt(9)
  buffer_load_dwordx4 v[72:75], v1, s[8:11], s39 offen offset:2048 nt
  s_waitcnt vmcnt(9)
  buffer_load_dwordx4 v[76:79], v1, s[8:11], s39 offen offset:3072 nt
  s_waitcnt vmcnt(5)
  buffer_load_dwordx4 v[80:83], v2, s[12:15], s39 offen offset:0 nt
  s_waitcnt vmcnt(5)
  buffer_load_dwordx4 v[84:87], v2, s[12:15], s39 offen offset:1024 nt
  v_perm_b32 v96, v228, v224, s34
  v_perm_b32 v97, v236, v232, s34
  v_perm_b32 v98, v244, v240, s34
  v_perm_b32 v99, v252, v248, s34
  v_perm_b32 v100, v228, v224, s35
  v_perm_b32 v101, v236, v232, s35
  v_perm_b32 v102, v244, v240, s35
  v_perm_b32 v103, v252, v248, s35
  v_perm_b32 v104, v229, v225, s34
  v_perm_b32 v105, v237, v233, s34
  v_perm_b32 v106, v245, v241, s34
  v_perm_b32 v107, v253, v249, s34
  v_perm_b32 v108, v229, v225, s35
  v_perm_b32 v109, v237, v233, s35
  v_perm_b32 v110, v245, v241, s35
  v_perm_b32 v111, v253, v249, s35
  v_perm_b32 v112, v230, v226, s34
  v_perm_b32 v113, v238, v234, s34
  v_perm_b32 v114, v246, v242, s34
  v_perm_b32 v115, v254, v250, s34
  v_perm_b32 v116, v230, v226, s35
  v_perm_b32 v117, v238, v234, s35
  v_perm_b32 v118, v246, v242, s35
  v_perm_b32 v119, v254, v250, s35
  v_perm_b32 v120, v231, v227, s34
  v_perm_b32 v121, v239, v235, s34
  v_perm_b32 v122, v247, v243, s34
  v_perm_b32 v123, v255, v251, s34
  v_perm_b32 v124, v231, v227, s35
  v_perm_b32 v125, v239, v235, s35
  v_perm_b32 v126, v247, v243, s35
  v_perm_b32 v127, v255, v251, s35
  v_mfma_f32_16x16x32_bf16 v[8:11], v[208:211], v[30:33], v[8:11]
  v_mfma_f32_16x16x32_bf16 v[12:15], v[208:211], v[28:31], v[12:15]
  v_mfma_f32_16x16x32_bf16 v[8:11], v[212:215], v[34:37], v[8:11]
  v_mfma_f32_16x16x32_bf16 v[12:15], v[212:215], v[32:35], v[12:15]
  v_mfma_f32_16x16x32_bf16 v[8:11], v[216:219], v[38:41], v[8:11]
  v_mfma_f32_16x16x32_bf16 v[12:15], v[216:219], v[36:39], v[12:15]
  v_mfma_f32_16x16x32_bf16 v[8:11], v[220:223], v[42:45], v[8:11]
  v_mfma_f32_16x16x32_bf16 v[12:15], v[220:223], v[40:43], v[12:15]
  s_waitcnt vmcnt(5)
  buffer_load_dwordx4 v[88:91], v2, s[12:15], s39 offen offset:2048 nt
  s_waitcnt vmcnt(5)
  buffer_load_dwordx4 v[92:95], v2, s[12:15], s39 offen offset:3072 nt
  s_add_u32 s39, s39, 0x20000
  s_and_b32 s39, s39, 0x1fffff
  s_or_b32 s39, s39, s45
  s_waitcnt vmcnt(5)
  buffer_load_dwordx4 v[128:131], v1, s[8:11], s39 offen offset:0 nt
  s_waitcnt vmcnt(5)
  buffer_load_dwordx4 v[132:135], v1, s[8:11], s39 offen offset:1024 nt
  s_add_u32 s33, s40, 32768
  buffer_load_dwordx4 v[224:227], v3, s[16:19], s33 offen
  s_add_u32 s33, s40, 40960
  buffer_load_dwordx4 v[228:231], v3, s[16:19], s33 offen
  s_add_u32 s33, s40, 49152
  buffer_load_dwordx4 v[232:235], v3, s[16:19], s33 offen
  s_add_u32 s33, s40, 57344
  buffer_load_dwordx4 v[236:239], v3, s[16:19], s33 offen
  v_mfma_f32_16x16x32_bf16 v[48:51], v[64:67], v[4:7], 0
  v_mfma_f32_16x16x32_bf16 v[52:55], v[68:71], v[4:7], 0
  v_mfma_f32_16x16x32_bf16 v[56:59], v[72:75], v[4:7], 0
  v_mfma_f32_16x16x32_bf16 v[60:63], v[76:79], v[4:7], 0
  s_nop 4
  v_mul_f32_dpp v24, v48, v20 quad_perm:[0,0,0,0] row_mask:0xf bank_mask:0xf
  v_mul_f32_dpp v25, v52, v20 quad_perm:[0,0,0,0] row_mask:0xf bank_mask:0xf
  v_mul_f32_dpp v26, v56, v20 quad_perm:[0,0,0,0] row_mask:0xf bank_mask:0xf
  v_mul_f32_dpp v27, v60, v20 quad_perm:[0,0,0,0] row_mask:0xf bank_mask:0xf
  v_fmac_f32_dpp v24, v49, v20 quad_perm:[1,1,1,1] row_mask:0xf bank_mask:0xf
  v_fmac_f32_dpp v25, v53, v20 quad_perm:[1,1,1,1] row_mask:0xf bank_mask:0xf
  v_fmac_f32_dpp v26, v57, v20 quad_perm:[1,1,1,1] row_mask:0xf bank_mask:0xf
  v_fmac_f32_dpp v27, v61, v20 quad_perm:[1,1,1,1] row_mask:0xf bank_mask:0xf
  v_fmac_f32_dpp v24, v50, v20 quad_perm:[2,2,2,2] row_mask:0xf bank_mask:0xf
  v_fmac_f32_dpp v25, v54, v20 quad_perm:[2,2,2,2] row_mask:0xf bank_mask:0xf
  v_fmac_f32_dpp v26, v58, v20 quad_perm:[2,2,2,2] row_mask:0xf bank_mask:0xf
  v_fmac_f32_dpp v27, v62, v20 quad_perm:[2,2,2,2] row_mask:0xf bank_mask:0xf
  v_fmac_f32_dpp v24, v51, v20 quad_perm:[3,3,3,3] row_mask:0xf bank_mask:0xf
  v_fmac_f32_dpp v25, v55, v20 quad_perm:[3,3,3,3] row_mask:0xf bank_mask:0xf
  v_fmac_f32_dpp v26, v59, v20 quad_perm:[3,3,3,3] row_mask:0xf bank_mask:0xf
  v_fmac_f32_dpp v27, v63, v20 quad_perm:[3,3,3,3] row_mask:0xf bank_mask:0xf
  v_max3_f32 v23, v24, v25, v26
  v_max3_f32 v23, v23, v27, v16
  v_mov_b32 v46, v23
  s_nop 1
  v_permlane16_swap_b32 v23, v46
  v_max_f32 v23, v23, v46
  v_mov_b32 v46, v23
  s_nop 1
  v_permlane32_swap_b32 v23, v46
  v_max_f32 v23, v23, v46
  v_sub_f32 v18, v16, v23
  v_sub_f32 v24, v24, v23
  v_sub_f32 v25, v25, v23
  v_sub_f32 v26, v26, v23
  v_sub_f32 v27, v27, v23
  v_exp_f32 v18, v18
  v_exp_f32 v24, v24
  v_exp_f32 v25, v25
  v_exp_f32 v26, v26
  v_exp_f32 v27, v27
  v_mov_b32 v16, v23
  v_pk_mul_f32 v[8:9], v[8:9], v[18:19] op_sel_hi:[1,0]
  v_pk_mul_f32 v[10:11], v[10:11], v[18:19] op_sel_hi:[1,0]
  v_pk_mul_f32 v[12:13], v[12:13], v[18:19] op_sel_hi:[1,0]
  v_pk_mul_f32 v[14:15], v[14:15], v[18:19] op_sel_hi:[1,0]
  v_fma_f32 v17, v17, v18, v24
  v_cvt_pk_bf16_f32 v31, v24, v24
  v_and_b32 v30, v21, v31
  v_and_b32 v31, v22, v31
  v_cvt_pk_bf16_f32 v35, v25, v25
  v_add_f32 v17, v17, v25
  v_and_b32 v34, v21, v35
  v_and_b32 v35, v22, v35
  v_cvt_pk_bf16_f32 v39, v26, v26
  v_add_f32 v17, v17, v26
  v_and_b32 v38, v21, v39
  v_and_b32 v39, v22, v39
  v_cvt_pk_bf16_f32 v43, v27, v27
  v_add_f32 v17, v17, v27
  v_and_b32 v42, v21, v43
  v_and_b32 v43, v22, v43
  s_waitcnt vmcnt(9)
  buffer_load_dwordx4 v[136:139], v1, s[8:11], s39 offen offset:2048 nt
  s_waitcnt vmcnt(9)
  buffer_load_dwordx4 v[140:143], v1, s[8:11], s39 offen offset:3072 nt
  s_waitcnt vmcnt(9)
  buffer_load_dwordx4 v[144:147], v2, s[12:15], s39 offen offset:0 nt
  s_waitcnt vmcnt(9)
  buffer_load_dwordx4 v[148:151], v2, s[12:15], s39 offen offset:1024 nt
  s_add_u32 s33, s40, 36864
  buffer_load_dwordx4 v[240:243], v3, s[16:19], s33 offen
  s_add_u32 s33, s40, 45056
  buffer_load_dwordx4 v[244:247], v3, s[16:19], s33 offen
  s_add_u32 s33, s40, 53248
  buffer_load_dwordx4 v[248:251], v3, s[16:19], s33 offen
  s_add_u32 s33, s40, 61440
  buffer_load_dwordx4 v[252:255], v3, s[16:19], s33 offen
  v_mfma_f32_16x16x32_bf16 v[8:11], v[80:83], v[30:33], v[8:11]
  v_mfma_f32_16x16x32_bf16 v[12:15], v[80:83], v[28:31], v[12:15]
  v_mfma_f32_16x16x32_bf16 v[8:11], v[84:87], v[34:37], v[8:11]
  v_mfma_f32_16x16x32_bf16 v[12:15], v[84:87], v[32:35], v[12:15]
  v_mfma_f32_16x16x32_bf16 v[8:11], v[88:91], v[38:41], v[8:11]
  v_mfma_f32_16x16x32_bf16 v[12:15], v[88:91], v[36:39], v[12:15]
  v_mfma_f32_16x16x32_bf16 v[8:11], v[92:95], v[42:45], v[8:11]
  v_mfma_f32_16x16x32_bf16 v[12:15], v[92:95], v[40:43], v[12:15]
  s_waitcnt vmcnt(13)
  buffer_load_dwordx4 v[152:155], v2, s[12:15], s39 offen offset:2048 nt
  s_waitcnt vmcnt(13)
  buffer_load_dwordx4 v[156:159], v2, s[12:15], s39 offen offset:3072 nt
  s_add_u32 s39, s39, 0x20000
  s_and_b32 s39, s39, 0x1fffff
  s_or_b32 s39, s39, s45
  s_waitcnt vmcnt(9)
  buffer_load_dwordx4 v[160:163], v1, s[8:11], s39 offen offset:0 nt
  s_waitcnt vmcnt(9)
  buffer_load_dwordx4 v[164:167], v1, s[8:11], s39 offen offset:1024 nt
  v_mfma_f32_16x16x32_bf16 v[48:51], v[128:131], v[4:7], 0
  v_mfma_f32_16x16x32_bf16 v[52:55], v[132:135], v[4:7], 0
  v_mfma_f32_16x16x32_bf16 v[56:59], v[136:139], v[4:7], 0
  v_mfma_f32_16x16x32_bf16 v[60:63], v[140:143], v[4:7], 0
  s_nop 4
  v_mul_f32_dpp v24, v48, v20 quad_perm:[0,0,0,0] row_mask:0xf bank_mask:0xf
  v_mul_f32_dpp v25, v52, v20 quad_perm:[0,0,0,0] row_mask:0xf bank_mask:0xf
  v_mul_f32_dpp v26, v56, v20 quad_perm:[0,0,0,0] row_mask:0xf bank_mask:0xf
  v_mul_f32_dpp v27, v60, v20 quad_perm:[0,0,0,0] row_mask:0xf bank_mask:0xf
  v_fmac_f32_dpp v24, v49, v20 quad_perm:[1,1,1,1] row_mask:0xf bank_mask:0xf
  v_fmac_f32_dpp v25, v53, v20 quad_perm:[1,1,1,1] row_mask:0xf bank_mask:0xf
  v_fmac_f32_dpp v26, v57, v20 quad_perm:[1,1,1,1] row_mask:0xf bank_mask:0xf
  v_fmac_f32_dpp v27, v61, v20 quad_perm:[1,1,1,1] row_mask:0xf bank_mask:0xf
  v_fmac_f32_dpp v24, v50, v20 quad_perm:[2,2,2,2] row_mask:0xf bank_mask:0xf
  v_fmac_f32_dpp v25, v54, v20 quad_perm:[2,2,2,2] row_mask:0xf bank_mask:0xf
  v_fmac_f32_dpp v26, v58, v20 quad_perm:[2,2,2,2] row_mask:0xf bank_mask:0xf
  v_fmac_f32_dpp v27, v62, v20 quad_perm:[2,2,2,2] row_mask:0xf bank_mask:0xf
  v_fmac_f32_dpp v24, v51, v20 quad_perm:[3,3,3,3] row_mask:0xf bank_mask:0xf
  v_fmac_f32_dpp v25, v55, v20 quad_perm:[3,3,3,3] row_mask:0xf bank_mask:0xf
  v_fmac_f32_dpp v26, v59, v20 quad_perm:[3,3,3,3] row_mask:0xf bank_mask:0xf
  v_fmac_f32_dpp v27, v63, v20 quad_perm:[3,3,3,3] row_mask:0xf bank_mask:0xf
  v_max3_f32 v23, v24, v25, v26
  v_max3_f32 v23, v23, v27, v16
  v_mov_b32 v46, v23
  s_nop 1
  v_permlane16_swap_b32 v23, v46
  v_max_f32 v23, v23, v46
  v_mov_b32 v46, v23
  s_nop 1
  v_permlane32_swap_b32 v23, v46
  v_max_f32 v23, v23, v46
  v_sub_f32 v18, v16, v23
  v_sub_f32 v24, v24, v23
  v_sub_f32 v25, v25, v23
  v_sub_f32 v26, v26, v23
  v_sub_f32 v27, v27, v23
  v_exp_f32 v18, v18
  v_exp_f32 v24, v24
  v_exp_f32 v25, v25
  v_exp_f32 v26, v26
  v_exp_f32 v27, v27
  v_mov_b32 v16, v23
  v_pk_mul_f32 v[8:9], v[8:9], v[18:19] op_sel_hi:[1,0]
  v_pk_mul_f32 v[10:11], v[10:11], v[18:19] op_sel_hi:[1,0]
  v_pk_mul_f32 v[12:13], v[12:13], v[18:19] op_sel_hi:[1,0]
  v_pk_mul_f32 v[14:15], v[14:15], v[18:19] op_sel_hi:[1,0]
  v_fma_f32 v17, v17, v18, v24
  v_cvt_pk_bf16_f32 v31, v24, v24
  v_and_b32 v30, v21, v31
  v_and_b32 v31, v22, v31
  v_cvt_pk_bf16_f32 v35, v25, v25
  v_add_f32 v17, v17, v25
  v_and_b32 v34, v21, v35
  v_and_b32 v35, v22, v35
  v_cvt_pk_bf16_f32 v39, v26, v26
  v_add_f32 v17, v17, v26
  v_and_b32 v38, v21, v39
  v_and_b32 v39, v22, v39
  v_cvt_pk_bf16_f32 v43, v27, v27
  v_add_f32 v17, v17, v27
  v_and_b32 v42, v21, v43
  v_and_b32 v43, v22, v43
  s_waitcnt vmcnt(9)
  buffer_load_dwordx4 v[168:171], v1, s[8:11], s39 offen offset:2048 nt
  s_waitcnt vmcnt(9)
  buffer_load_dwordx4 v[172:175], v1, s[8:11], s39 offen offset:3072 nt
  s_waitcnt vmcnt(5)
  buffer_load_dwordx4 v[176:179], v2, s[12:15], s39 offen offset:0 nt
  s_waitcnt vmcnt(5)
  buffer_load_dwordx4 v[180:183], v2, s[12:15], s39 offen offset:1024 nt
  v_perm_b32 v192, v228, v224, s34
  v_perm_b32 v193, v236, v232, s34
  v_perm_b32 v194, v244, v240, s34
  v_perm_b32 v195, v252, v248, s34
  v_perm_b32 v196, v228, v224, s35
  v_perm_b32 v197, v236, v232, s35
  v_perm_b32 v198, v244, v240, s35
  v_perm_b32 v199, v252, v248, s35
  v_perm_b32 v200, v229, v225, s34
  v_perm_b32 v201, v237, v233, s34
  v_perm_b32 v202, v245, v241, s34
  v_perm_b32 v203, v253, v249, s34
  v_perm_b32 v204, v229, v225, s35
  v_perm_b32 v205, v237, v233, s35
  v_perm_b32 v206, v245, v241, s35
  v_perm_b32 v207, v253, v249, s35
  v_perm_b32 v208, v230, v226, s34
  v_perm_b32 v209, v238, v234, s34
  v_perm_b32 v210, v246, v242, s34
  v_perm_b32 v211, v254, v250, s34
  v_perm_b32 v212, v230, v226, s35
  v_perm_b32 v213, v238, v234, s35
  v_perm_b32 v214, v246, v242, s35
  v_perm_b32 v215, v254, v250, s35
  v_perm_b32 v216, v231, v227, s34
  v_perm_b32 v217, v239, v235, s34
  v_perm_b32 v218, v247, v243, s34
  v_perm_b32 v219, v255, v251, s34
  v_perm_b32 v220, v231, v227, s35
  v_perm_b32 v221, v239, v235, s35
  v_perm_b32 v222, v247, v243, s35
  v_perm_b32 v223, v255, v251, s35
  v_bfe_u32 v23, v0, 2, 2
  v_mul_u32_u24 v90, 2176, v23
  v_add_u32 v91, 8704, v90
  v_lshlrev_b32 v93, 8, v23
  v_lshlrev_b32 v94, 5, v23
  v_and_b32 v23, 3, v0
  v_lshl_or_b32 v93, v23, 6, v93
  v_lshrrev_b32 v46, 4, v0
  v_lshl_or_b32 v23, v46, 2, v23
  v_lshl_add_u32 v88, v23, 4, v90
  v_add_u32 v89, 8704, v88
  s_lshr_b32 s42, s7, 1
  s_and_b32 s43, s7, 1
  s_mul_i32 s30, s38, 17408
  s_add_u32 s30, s30, 532480
  s_lshl_b32 s31, s42, 4
  s_add_u32 s31, s31, s30
  s_lshl_b32 s42, s42, 8
  s_lshl_b32 s43, s43, 10
  s_add_u32 s30, s30, s42
  s_add_u32 s30, s30, s43
  v_and_b32 v92, 15, v0
  v_lshlrev_b32 v92, 5, v92
  v_lshl_add_u32 v92, v46, 4, v92
  s_lshl_b32 s32, s38, 3
  s_add_u32 s32, s32, s7
  s_lshl_b32 s32, s32, 11
  s_lshl_b32 s33, s3, 9
  s_add_u32 s32, s32, s33
  s_add_u32 s32, s32, 1113600
  s_mov_b32 s49, 0x00ff00ff
  s_bitcmp1_b32 s4, 0
  s_cselect_b32 s49, 0xff00ff00, s49
  s_lshr_b32 s50, s4, 1
  s_add_u32 s50, s50, 1
  s_cmp_eq_u32 s50, s3
  s_cselect_b32 s49, s49, 0
  s_cmp_eq_u32 s48, 0
  s_cselect_b32 s49, s49, 0
  s_not_b32 s50, s49
  v_cmp_gt_u32 s[46:47], 16, v0
  v_bfe_u32 v23, v0, 4, 1
  v_lshl_or_b32 v93, v23, 5, v93
  v_lshrrev_b32 v23, 5, v0
  v_lshl_or_b32 v93, v23, 10, v93
  v_bfe_u32 v23, v0, 1, 2
  v_lshlrev_b32 v23, 4, v23
  v_xor_b32 v93, v23, v93
  s_lshl_b32 s33, s3, 11
  v_add_u32 v93, s33, v93
  v_xor_b32 v95, 16, v93
  s_lshl_b32 s33, s3, 3
  v_add_u32 v94, s33, v94
  v_mfma_f32_16x16x32_bf16 v[8:11], v[144:147], v[30:33], v[8:11]
  v_mfma_f32_16x16x32_bf16 v[12:15], v[144:147], v[28:31], v[12:15]
  v_mfma_f32_16x16x32_bf16 v[8:11], v[148:151], v[34:37], v[8:11]
  v_mfma_f32_16x16x32_bf16 v[12:15], v[148:151], v[32:35], v[12:15]
  v_mfma_f32_16x16x32_bf16 v[8:11], v[152:155], v[38:41], v[8:11]
  v_mfma_f32_16x16x32_bf16 v[12:15], v[152:155], v[36:39], v[12:15]
  v_mfma_f32_16x16x32_bf16 v[8:11], v[156:159], v[42:45], v[8:11]
  v_mfma_f32_16x16x32_bf16 v[12:15], v[156:159], v[40:43], v[12:15]
  buffer_load_dwordx4 v[184:187], v2, s[12:15], s39 offen offset:2048 nt
  buffer_load_dwordx4 v[188:191], v2, s[12:15], s39 offen offset:3072 nt
  s_add_u32 s39, s39, 0x20000
  s_and_b32 s39, s39, 0x1fffff
  s_or_b32 s39, s39, s45
  s_waitcnt vmcnt(7)
  buffer_load_dwordx4 v[224:227], v1, s[8:11], s39 offen offset:0 nt
  s_waitcnt vmcnt(7)
  buffer_load_dwordx4 v[228:231], v1, s[8:11], s39 offen offset:1024 nt
  s_waitcnt vmcnt(7)
  buffer_load_dwordx4 v[232:235], v1, s[8:11], s39 offen offset:2048 nt
  s_waitcnt vmcnt(7)
  buffer_load_dwordx4 v[236:239], v1, s[8:11], s39 offen offset:3072 nt
  v_mov_b32 v63, 3
  ds_write_b32 v28, v63 offset:42560
  v_mfma_f32_16x16x32_bf16 v[48:51], v[160:163], v[4:7], 0
  v_mfma_f32_16x16x32_bf16 v[52:55], v[164:167], v[4:7], 0
  v_mfma_f32_16x16x32_bf16 v[56:59], v[168:171], v[4:7], 0
  v_mfma_f32_16x16x32_bf16 v[60:63], v[172:175], v[4:7], 0
  s_nop 4
  v_mul_f32_dpp v24, v48, v20 quad_perm:[0,0,0,0] row_mask:0xf bank_mask:0xf
  v_mul_f32_dpp v25, v52, v20 quad_perm:[0,0,0,0] row_mask:0xf bank_mask:0xf
  v_mul_f32_dpp v26, v56, v20 quad_perm:[0,0,0,0] row_mask:0xf bank_mask:0xf
  v_mul_f32_dpp v27, v60, v20 quad_perm:[0,0,0,0] row_mask:0xf bank_mask:0xf
  v_fmac_f32_dpp v24, v49, v20 quad_perm:[1,1,1,1] row_mask:0xf bank_mask:0xf
  v_fmac_f32_dpp v25, v53, v20 quad_perm:[1,1,1,1] row_mask:0xf bank_mask:0xf
  v_fmac_f32_dpp v26, v57, v20 quad_perm:[1,1,1,1] row_mask:0xf bank_mask:0xf
  v_fmac_f32_dpp v27, v61, v20 quad_perm:[1,1,1,1] row_mask:0xf bank_mask:0xf
  v_fmac_f32_dpp v24, v50, v20 quad_perm:[2,2,2,2] row_mask:0xf bank_mask:0xf
  v_fmac_f32_dpp v25, v54, v20 quad_perm:[2,2,2,2] row_mask:0xf bank_mask:0xf
  v_fmac_f32_dpp v26, v58, v20 quad_perm:[2,2,2,2] row_mask:0xf bank_mask:0xf
  v_fmac_f32_dpp v27, v62, v20 quad_perm:[2,2,2,2] row_mask:0xf bank_mask:0xf
  v_fmac_f32_dpp v24, v51, v20 quad_perm:[3,3,3,3] row_mask:0xf bank_mask:0xf
  v_fmac_f32_dpp v25, v55, v20 quad_perm:[3,3,3,3] row_mask:0xf bank_mask:0xf
  v_fmac_f32_dpp v26, v59, v20 quad_perm:[3,3,3,3] row_mask:0xf bank_mask:0xf
  v_fmac_f32_dpp v27, v63, v20 quad_perm:[3,3,3,3] row_mask:0xf bank_mask:0xf
  v_max3_f32 v23, v24, v25, v26
  v_max3_f32 v23, v23, v27, v16
  v_mov_b32 v46, v23
  s_nop 1
  v_permlane16_swap_b32 v23, v46
  v_max_f32 v23, v23, v46
  v_mov_b32 v46, v23
  s_nop 1
  v_permlane32_swap_b32 v23, v46
  v_max_f32 v23, v23, v46
  v_sub_f32 v18, v16, v23
  v_sub_f32 v24, v24, v23
  v_sub_f32 v25, v25, v23
  v_sub_f32 v26, v26, v23
  v_sub_f32 v27, v27, v23
  v_exp_f32 v18, v18
  v_exp_f32 v24, v24
  v_exp_f32 v25, v25
  v_exp_f32 v26, v26
  v_exp_f32 v27, v27
  v_mov_b32 v16, v23
  v_pk_mul_f32 v[8:9], v[8:9], v[18:19] op_sel_hi:[1,0]
  v_pk_mul_f32 v[10:11], v[10:11], v[18:19] op_sel_hi:[1,0]
  v_pk_mul_f32 v[12:13], v[12:13], v[18:19] op_sel_hi:[1,0]
  v_pk_mul_f32 v[14:15], v[14:15], v[18:19] op_sel_hi:[1,0]
  v_fma_f32 v17, v17, v18, v24
  v_cvt_pk_bf16_f32 v31, v24, v24
  v_and_b32 v30, v21, v31
  v_and_b32 v31, v22, v31
  v_cvt_pk_bf16_f32 v35, v25, v25
  v_add_f32 v17, v17, v25
  v_and_b32 v34, v21, v35
  v_and_b32 v35, v22, v35
  v_cvt_pk_bf16_f32 v39, v26, v26
  v_add_f32 v17, v17, v26
  v_and_b32 v38, v21, v39
  v_and_b32 v39, v22, v39
  v_cvt_pk_bf16_f32 v43, v27, v27
  v_add_f32 v17, v17, v27
  v_and_b32 v42, v21, v43
  v_and_b32 v43, v22, v43
  s_add_u32 s41, s39, 0x20000
  s_and_b32 s41, s41, 0x1fffff
  s_or_b32 s41, s41, s45
  s_waitcnt vmcnt(7)
  buffer_load_dwordx4 v[128:131], v1, s[8:11], s41 offen offset:0 nt
  s_waitcnt vmcnt(7)
  buffer_load_dwordx4 v[132:135], v1, s[8:11], s41 offen offset:1024 nt
  s_waitcnt vmcnt(7)
  buffer_load_dwordx4 v[136:139], v1, s[8:11], s41 offen offset:2048 nt
  s_waitcnt vmcnt(7)
  buffer_load_dwordx4 v[140:143], v1, s[8:11], s41 offen offset:3072 nt
  v_mfma_f32_16x16x32_bf16 v[8:11], v[176:179], v[30:33], v[8:11]
  v_mfma_f32_16x16x32_bf16 v[12:15], v[176:179], v[28:31], v[12:15]
  v_mfma_f32_16x16x32_bf16 v[8:11], v[180:183], v[34:37], v[8:11]
  v_mfma_f32_16x16x32_bf16 v[12:15], v[180:183], v[32:35], v[12:15]
  v_mfma_f32_16x16x32_bf16 v[8:11], v[184:187], v[38:41], v[8:11]
  v_mfma_f32_16x16x32_bf16 v[12:15], v[184:187], v[36:39], v[12:15]
  v_mfma_f32_16x16x32_bf16 v[8:11], v[188:191], v[42:45], v[8:11]
  v_mfma_f32_16x16x32_bf16 v[12:15], v[188:191], v[40:43], v[12:15]
  v_mov_b32 v160, 0
  v_mov_b32 v161, 0
  v_mov_b32 v164, 0
  v_mov_b32 v165, 0
  v_mov_b32 v168, 0
  v_mov_b32 v169, 0
  v_mov_b32 v172, 0
  v_mov_b32 v173, 0
  v_mov_b32 v176, 0
  v_mov_b32 v177, 0
  s_waitcnt vmcnt(7)
  buffer_load_dwordx4 v[240:243], v2, s[12:15], s39 offen offset:0 nt
  s_waitcnt vmcnt(7)
  buffer_load_dwordx4 v[244:247], v2, s[12:15], s39 offen offset:1024 nt
  s_waitcnt vmcnt(7)
  buffer_load_dwordx4 v[248:251], v2, s[12:15], s39 offen offset:2048 nt
  s_waitcnt vmcnt(7)
  buffer_load_dwordx4 v[252:255], v2, s[12:15], s39 offen offset:3072 nt
  v_mfma_f32_16x16x32_bf16 v[48:51], v[224:227], v[4:7], 0
  v_mfma_f32_16x16x32_bf16 v[52:55], v[228:231], v[4:7], 0
  v_mfma_f32_16x16x32_bf16 v[56:59], v[232:235], v[4:7], 0
  v_mfma_f32_16x16x32_bf16 v[60:63], v[236:239], v[4:7], 0
  s_nop 4
  v_mul_f32_dpp v24, v48, v20 quad_perm:[0,0,0,0] row_mask:0xf bank_mask:0xf
  v_mul_f32_dpp v25, v52, v20 quad_perm:[0,0,0,0] row_mask:0xf bank_mask:0xf
  v_mul_f32_dpp v26, v56, v20 quad_perm:[0,0,0,0] row_mask:0xf bank_mask:0xf
  v_mul_f32_dpp v27, v60, v20 quad_perm:[0,0,0,0] row_mask:0xf bank_mask:0xf
  v_fmac_f32_dpp v24, v49, v20 quad_perm:[1,1,1,1] row_mask:0xf bank_mask:0xf
  v_fmac_f32_dpp v25, v53, v20 quad_perm:[1,1,1,1] row_mask:0xf bank_mask:0xf
  v_fmac_f32_dpp v26, v57, v20 quad_perm:[1,1,1,1] row_mask:0xf bank_mask:0xf
  v_fmac_f32_dpp v27, v61, v20 quad_perm:[1,1,1,1] row_mask:0xf bank_mask:0xf
  v_fmac_f32_dpp v24, v50, v20 quad_perm:[2,2,2,2] row_mask:0xf bank_mask:0xf
  v_fmac_f32_dpp v25, v54, v20 quad_perm:[2,2,2,2] row_mask:0xf bank_mask:0xf
  v_fmac_f32_dpp v26, v58, v20 quad_perm:[2,2,2,2] row_mask:0xf bank_mask:0xf
  v_fmac_f32_dpp v27, v62, v20 quad_perm:[2,2,2,2] row_mask:0xf bank_mask:0xf
  v_fmac_f32_dpp v24, v51, v20 quad_perm:[3,3,3,3] row_mask:0xf bank_mask:0xf
  v_fmac_f32_dpp v25, v55, v20 quad_perm:[3,3,3,3] row_mask:0xf bank_mask:0xf
  v_fmac_f32_dpp v26, v59, v20 quad_perm:[3,3,3,3] row_mask:0xf bank_mask:0xf
  v_fmac_f32_dpp v27, v63, v20 quad_perm:[3,3,3,3] row_mask:0xf bank_mask:0xf
  s_waitcnt vmcnt(7)
  buffer_load_dwordx4 v[144:147], v2, s[12:15], s41 offen offset:0 nt
  s_waitcnt vmcnt(7)
  buffer_load_dwordx4 v[148:151], v2, s[12:15], s41 offen offset:1024 nt
  s_waitcnt vmcnt(7)
  buffer_load_dwordx4 v[152:155], v2, s[12:15], s41 offen offset:2048 nt
  s_waitcnt vmcnt(7)
  buffer_load_dwordx4 v[156:159], v2, s[12:15], s41 offen offset:3072 nt
  v_mfma_f32_16x16x32_bf16 v[48:51], v[128:131], v[4:7], 0
  v_mfma_f32_16x16x32_bf16 v[52:55], v[132:135], v[4:7], 0
  v_mfma_f32_16x16x32_bf16 v[56:59], v[136:139], v[4:7], 0
  v_mfma_f32_16x16x32_bf16 v[60:63], v[140:143], v[4:7], 0
  s_nop 4
  v_mul_f32_dpp v180, v48, v20 quad_perm:[0,0,0,0] row_mask:0xf bank_mask:0xf
  v_mul_f32_dpp v181, v52, v20 quad_perm:[0,0,0,0] row_mask:0xf bank_mask:0xf
  v_mul_f32_dpp v182, v56, v20 quad_perm:[0,0,0,0] row_mask:0xf bank_mask:0xf
  v_mul_f32_dpp v183, v60, v20 quad_perm:[0,0,0,0] row_mask:0xf bank_mask:0xf
  v_fmac_f32_dpp v180, v49, v20 quad_perm:[1,1,1,1] row_mask:0xf bank_mask:0xf
  v_fmac_f32_dpp v181, v53, v20 quad_perm:[1,1,1,1] row_mask:0xf bank_mask:0xf
  v_fmac_f32_dpp v182, v57, v20 quad_perm:[1,1,1,1] row_mask:0xf bank_mask:0xf
  v_fmac_f32_dpp v183, v61, v20 quad_perm:[1,1,1,1] row_mask:0xf bank_mask:0xf
  v_fmac_f32_dpp v180, v50, v20 quad_perm:[2,2,2,2] row_mask:0xf bank_mask:0xf
  v_fmac_f32_dpp v181, v54, v20 quad_perm:[2,2,2,2] row_mask:0xf bank_mask:0xf
  v_fmac_f32_dpp v182, v58, v20 quad_perm:[2,2,2,2] row_mask:0xf bank_mask:0xf
  v_fmac_f32_dpp v183, v62, v20 quad_perm:[2,2,2,2] row_mask:0xf bank_mask:0xf
  v_fmac_f32_dpp v180, v51, v20 quad_perm:[3,3,3,3] row_mask:0xf bank_mask:0xf
  v_fmac_f32_dpp v181, v55, v20 quad_perm:[3,3,3,3] row_mask:0xf bank_mask:0xf
  v_fmac_f32_dpp v182, v59, v20 quad_perm:[3,3,3,3] row_mask:0xf bank_mask:0xf
  v_fmac_f32_dpp v183, v63, v20 quad_perm:[3,3,3,3] row_mask:0xf bank_mask:0xf
  v_max3_f32 v23, v24, v25, v26
  v_max3_f32 v23, v23, v27, v180
  v_max3_f32 v23, v23, v181, v182
  v_max3_f32 v23, v23, v183, v16
  v_mov_b32 v46, v23
  s_nop 1
  v_permlane16_swap_b32 v23, v46
  v_max_f32 v23, v23, v46
  v_mov_b32 v46, v23
  s_nop 1
  v_permlane32_swap_b32 v23, v46
  v_max_f32 v23, v23, v46
  v_sub_f32 v18, v16, v23
  v_sub_f32 v24, v24, v23
  v_sub_f32 v25, v25, v23
  v_sub_f32 v26, v26, v23
  v_sub_f32 v27, v27, v23
  v_sub_f32 v180, v180, v23
  v_sub_f32 v181, v181, v23
  v_sub_f32 v182, v182, v23
  v_sub_f32 v183, v183, v23
  v_exp_f32 v18, v18
  v_exp_f32 v24, v24
  v_exp_f32 v25, v25
  v_exp_f32 v26, v26
  v_exp_f32 v27, v27
  v_exp_f32 v180, v180
  v_exp_f32 v181, v181
  v_exp_f32 v182, v182
  v_exp_f32 v183, v183
  v_mov_b32 v16, v23
  v_pk_mul_f32 v[8:9], v[8:9], v[18:19] op_sel_hi:[1,0]
  v_pk_mul_f32 v[10:11], v[10:11], v[18:19] op_sel_hi:[1,0]
  v_pk_mul_f32 v[12:13], v[12:13], v[18:19] op_sel_hi:[1,0]
  v_pk_mul_f32 v[14:15], v[14:15], v[18:19] op_sel_hi:[1,0]
  v_fma_f32 v17, v17, v18, v24
  v_cvt_pk_bf16_f32 v31, v24, v24
  v_and_b32 v30, v21, v31
  v_and_b32 v31, v22, v31
  v_cvt_pk_bf16_f32 v35, v25, v25
  v_add_f32 v17, v17, v25
  v_and_b32 v34, v21, v35
  v_and_b32 v35, v22, v35
  v_cvt_pk_bf16_f32 v39, v26, v26
  v_add_f32 v17, v17, v26
  v_and_b32 v38, v21, v39
  v_and_b32 v39, v22, v39
  v_cvt_pk_bf16_f32 v43, v27, v27
  v_add_f32 v17, v17, v27
  v_and_b32 v42, v21, v43
  v_and_b32 v43, v22, v43
  v_cvt_pk_bf16_f32 v163, v180, v180
  v_add_f32 v17, v17, v180
  v_and_b32 v162, v21, v163
  v_and_b32 v163, v22, v163
  v_cvt_pk_bf16_f32 v167, v181, v181
  v_add_f32 v17, v17, v181
  v_and_b32 v166, v21, v167
  v_and_b32 v167, v22, v167
  v_cvt_pk_bf16_f32 v171, v182, v182
  v_add_f32 v17, v17, v182
  v_and_b32 v170, v21, v171
  v_and_b32 v171, v22, v171
  v_cvt_pk_bf16_f32 v175, v183, v183
  v_add_f32 v17, v17, v183
  v_and_b32 v174, v21, v175
  v_and_b32 v175, v22, v175
  v_mov_b32 v46, v17
  s_nop 1
  v_permlane16_swap_b32 v17, v46
  v_add_f32 v17, v17, v46
  v_mov_b32 v46, v17
  s_nop 1
  v_permlane32_swap_b32 v17, v46
  v_add_f32 v17, v17, v46
  ds_write_b64 v94, v[16:17] offset:50936
  v_mov_b32 v23, 1
  s_mov_b64 exec, 1
  ds_add_u32 v28, v23 offset:42568
  s_mov_b64 exec, -1
  s_waitcnt vmcnt(4)
  v_mfma_f32_16x16x32_bf16 v[8:11], v[240:243], v[30:33], v[8:11]
  v_mfma_f32_16x16x32_bf16 v[12:15], v[240:243], v[28:31], v[12:15]
  v_mfma_f32_16x16x32_bf16 v[8:11], v[244:247], v[34:37], v[8:11]
  v_mfma_f32_16x16x32_bf16 v[12:15], v[244:247], v[32:35], v[12:15]
  v_mfma_f32_16x16x32_bf16 v[8:11], v[248:251], v[38:41], v[8:11]
  v_mfma_f32_16x16x32_bf16 v[12:15], v[248:251], v[36:39], v[12:15]
  v_mfma_f32_16x16x32_bf16 v[8:11], v[252:255], v[42:45], v[8:11]
  v_mfma_f32_16x16x32_bf16 v[12:15], v[252:255], v[40:43], v[12:15]
  s_waitcnt vmcnt(3)
  v_mfma_f32_16x16x32_bf16 v[8:11], v[144:147], v[162:165], v[8:11]
  v_mfma_f32_16x16x32_bf16 v[12:15], v[144:147], v[160:163], v[12:15]
  s_waitcnt vmcnt(2)
  v_mfma_f32_16x16x32_bf16 v[8:11], v[148:151], v[166:169], v[8:11]
  v_mfma_f32_16x16x32_bf16 v[12:15], v[148:151], v[164:167], v[12:15]
  s_waitcnt vmcnt(1)
  v_mfma_f32_16x16x32_bf16 v[8:11], v[152:155], v[170:173], v[8:11]
  v_mfma_f32_16x16x32_bf16 v[12:15], v[152:155], v[168:171], v[12:15]
  s_waitcnt vmcnt(0)
  v_mfma_f32_16x16x32_bf16 v[8:11], v[156:159], v[174:177], v[8:11]
  v_mfma_f32_16x16x32_bf16 v[12:15], v[156:159], v[172:175], v[12:15]
  s_nop 6
  ds_write_b128 v93, v[8:11] offset:40704
  ds_write_b128 v95, v[12:15] offset:40704
  s_waitcnt lgkmcnt(0)
  s_barrier
  buffer_load_dwordx4 v[72:75], v90, s[20:23], s31 offen offset:2048 sc1
  buffer_load_dwordx4 v[76:79], v91, s[20:23], s31 offen offset:2048 sc1
  s_mov_b32 s44, 1048576
L_poll1:
  s_waitcnt vmcnt(0)
  v_xor_b32 v72, v47, v72
  v_xor_b32 v73, v47, v73
  v_xor_b32 v74, v47, v74
  v_xor_b32 v75, v47, v75
  v_xor_b32 v76, v47, v76
  v_xor_b32 v77, v47, v77
  v_xor_b32 v78, v47, v78
  v_xor_b32 v79, v47, v79
  v_or3_b32 v80, v72, v73, v74
  v_or3_b32 v80, v80, v75, v76
  v_or3_b32 v80, v80, v77, v78
  v_bitop3_b32 v80, v80, v79, s36 bitop3:0xa8
  v_cmp_ne_u32 vcc, 0, v80
  s_cbranch_vccz L_poll1_done
  s_mov_b64 exec, vcc
  buffer_load_dwordx4 v[72:75], v90, s[20:23], s31 offen offset:2048 sc1
  buffer_load_dwordx4 v[76:79], v91, s[20:23], s31 offen offset:2048 sc1
  s_sub_u32 s44, s44, 1
  s_cbranch_scc0 L_poll1
  s_waitcnt vmcnt(0)
L_poll1_done:
  s_mov_b64 exec, -1
  v_max_f32 v80, v72, v76
  s_nop 1
  v_max_f32_dpp v80, v80, v80 row_ror:4 row_mask:0xf bank_mask:0xf
  s_nop 1
  v_max_f32_dpp v80, v80, v80 row_ror:8 row_mask:0xf bank_mask:0xf
  v_sub_f32 v82, v72, v80
  v_sub_f32 v84, v76, v80
  v_exp_f32 v82, v82
  v_exp_f32 v84, v84
  v_mul_f32 v81, v82, v73
  v_fmac_f32 v81, v84, v77
  buffer_load_dwordx4 v[64:67], v88, s[20:23], s30 offen sc1
  buffer_load_dwordx4 v[68:71], v89, s[20:23], s30 offen sc1
  v_add_f32_dpp v81, v81, v81 row_ror:4 row_mask:0xf bank_mask:0xf
  s_nop 1
  v_add_f32_dpp v81, v81, v81 row_ror:8 row_mask:0xf bank_mask:0xf
  v_rcp_f32 v81, v81
  s_nop 0
  v_mul_f32 v82, v82, v81
  v_mul_f32 v84, v84, v81
  s_mov_b32 s44, 1048576
L_poll2:
  s_waitcnt vmcnt(0)
  v_xor_b32 v64, v47, v64
  v_xor_b32 v65, v47, v65
  v_xor_b32 v66, v47, v66
  v_xor_b32 v67, v47, v67
  v_xor_b32 v68, v47, v68
  v_xor_b32 v69, v47, v69
  v_xor_b32 v70, v47, v70
  v_xor_b32 v71, v47, v71
  v_or3_b32 v85, v64, v65, v66
  v_or3_b32 v85, v85, v67, v68
  v_or3_b32 v85, v85, v69, v70
  v_bitop3_b32 v85, v85, v71, s36 bitop3:0xa8
  v_cmp_ne_u32 vcc, 0, v85
  s_cbranch_vccz L_poll2_done
  s_mov_b64 exec, vcc
  buffer_load_dwordx4 v[64:67], v88, s[20:23], s30 offen sc1
  buffer_load_dwordx4 v[68:71], v89, s[20:23], s30 offen sc1
  s_sub_u32 s44, s44, 1
  s_cbranch_scc0 L_poll2
  s_waitcnt vmcnt(0)
L_poll2_done:
  s_mov_b64 exec, -1
  v_pk_mul_f32 v[64:65], v[64:65], v[82:83] op_sel_hi:[1,0]
  v_pk_mul_f32 v[66:67], v[66:67], v[82:83] op_sel_hi:[1,0]
  v_pk_fma_f32 v[64:65], v[68:69], v[84:85], v[64:65] op_sel_hi:[1,0,1]
  v_pk_fma_f32 v[66:67], v[70:71], v[84:85], v[66:67] op_sel_hi:[1,0,1]
  s_nop 0
  v_add_f32_dpp v64, v64, v64 row_ror:4 row_mask:0xf bank_mask:0xf
  v_add_f32_dpp v65, v65, v65 row_ror:4 row_mask:0xf bank_mask:0xf
  v_add_f32_dpp v66, v66, v66 row_ror:4 row_mask:0xf bank_mask:0xf
  v_add_f32_dpp v67, v67, v67 row_ror:4 row_mask:0xf bank_mask:0xf
  v_add_f32_dpp v64, v64, v64 row_ror:8 row_mask:0xf bank_mask:0xf
  v_add_f32_dpp v65, v65, v65 row_ror:8 row_mask:0xf bank_mask:0xf
  v_add_f32_dpp v66, v66, v66 row_ror:8 row_mask:0xf bank_mask:0xf
  v_add_f32_dpp v67, v67, v67 row_ror:8 row_mask:0xf bank_mask:0xf
  v_cvt_pk_bf16_f32 v68, v64, v65
  v_cvt_pk_bf16_f32 v69, v66, v67
  s_nop 0
  v_mov_b32_dpp v72, v68 quad_perm:[0,0,0,0] row_mask:0xf bank_mask:0xf
  v_mov_b32_dpp v73, v69 quad_perm:[0,0,0,0] row_mask:0xf bank_mask:0xf
  v_mov_b32_dpp v74, v68 quad_perm:[1,1,1,1] row_mask:0xf bank_mask:0xf
  v_mov_b32_dpp v75, v69 quad_perm:[1,1,1,1] row_mask:0xf bank_mask:0xf
  s_nop 1
  v_mfma_f32_16x16x32_bf16 v[224:227], v[72:75], v[96:99], 0
  v_mov_b32_dpp v76, v68 quad_perm:[2,2,2,2] row_mask:0xf bank_mask:0xf
  v_mfma_f32_16x16x32_bf16 v[228:231], v[72:75], v[100:103], 0
  v_mov_b32_dpp v77, v69 quad_perm:[2,2,2,2] row_mask:0xf bank_mask:0xf
  v_mfma_f32_16x16x32_bf16 v[232:235], v[72:75], v[104:107], 0
  v_mov_b32_dpp v78, v68 quad_perm:[3,3,3,3] row_mask:0xf bank_mask:0xf
  v_mfma_f32_16x16x32_bf16 v[236:239], v[72:75], v[108:111], 0
  v_mov_b32_dpp v79, v69 quad_perm:[3,3,3,3] row_mask:0xf bank_mask:0xf
  v_mfma_f32_16x16x32_bf16 v[240:243], v[72:75], v[112:115], 0
  v_mfma_f32_16x16x32_bf16 v[244:247], v[72:75], v[116:119], 0
  v_mfma_f32_16x16x32_bf16 v[248:251], v[72:75], v[120:123], 0
  v_mfma_f32_16x16x32_bf16 v[252:255], v[72:75], v[124:127], 0
  v_mfma_f32_16x16x32_bf16 v[224:227], v[76:79], v[192:195], v[224:227]
  v_mfma_f32_16x16x32_bf16 v[240:243], v[76:79], v[208:211], v[240:243]
  v_mfma_f32_16x16x32_bf16 v[228:231], v[76:79], v[196:199], v[228:231]
  v_mfma_f32_16x16x32_bf16 v[244:247], v[76:79], v[212:215], v[244:247]
  v_mfma_f32_16x16x32_bf16 v[232:235], v[76:79], v[200:203], v[232:235]
  v_mfma_f32_16x16x32_bf16 v[248:251], v[76:79], v[216:219], v[248:251]
  v_mfma_f32_16x16x32_bf16 v[236:239], v[76:79], v[204:207], v[236:239]
  v_mfma_f32_16x16x32_bf16 v[252:255], v[76:79], v[220:223], v[252:255]
  s_nop 1
  v_cndmask_b32 v64, v240, v224, s[46:47]
  v_bfi_b32 v64, s36, v47, v64
  v_cndmask_b32 v65, v244, v228, s[46:47]
  v_bfi_b32 v65, s36, v47, v65
  v_cndmask_b32 v66, v248, v232, s[46:47]
  v_bfi_b32 v66, s36, v47, v66
  v_cndmask_b32 v67, v252, v236, s[46:47]
  v_bfi_b32 v67, s36, v47, v67
  s_mov_b32 exec_hi, 0
  s_barrier
  s_mov_b32 exec_lo, s50
  buffer_store_dwordx4 v[64:67], v92, s[20:23], s32 offen sc1
  s_cmp_eq_u32 s49, 0
  s_cbranch_scc1 L_no_loc
  s_mov_b32 exec_lo, s49
  buffer_store_dwordx4 v[64:67], v92, s[20:23], s32 offen
L_no_loc:
  s_endpgm
L_helper:
  s_mov_b32 s26, 0x1000
  s_mov_b32 s27, 0x20000
  s_mov_b32 s30, 0x400000
  s_mov_b32 s31, 0x20000
  s_mov_b32 s22, 0x10000000
  s_mov_b32 s23, 0x20000
  v_lshrrev_b32 v2, 4, v0
  v_and_b32 v1, 15, v0
  v_lshlrev_b32 v19, 4, v1
  v_lshl_or_b32 v3, v2, 10, v19
  v_lshrrev_b32 v36, 3, v0
  v_and_b32 v37, 7, v0
  v_lshlrev_b32 v37, 4, v37
  v_lshl_or_b32 v4, v36, 13, v37
  v_mov_b32 v6, 0
  s_lshl_b32 s60, s4, 3
  s_add_u32 s60, s60, s7
  s_lshl_b32 s61, s60, 4
  s_lshl_b32 s60, s60, 7
  s_lshl_b32 s62, s6, 20
  s_add_u32 s60, s60, s62
  s_getpc_b64 s[88:89]
L_pc:
  s_sub_u32 s88, s88, L_pc-recurrent_scan__gqa_block_cached__mixer_channel_mlp__decode_kernel
  s_subb_u32 s89, s89, 0
  v_lshl_add_u32 v10, s5, 3, v0
  v_lshlrev_b32 v10, 7, v10
  v_min_u32 v10, L_code_end-recurrent_scan__gqa_block_cached__mixer_channel_mlp__decode_kernel-4, v10
  v_mov_b32 v11, s89
  v_add_co_u32 v10, vcc, s88, v10
  s_nop 1
  v_addc_co_u32 v11, vcc, 0, v11, vcc
  s_mov_b64 exec, 0xff
  global_load_dword v12, v[10:11], off
  s_mov_b64 exec, -1
  s_waitcnt lgkmcnt(0)
  buffer_load_dwordx4 v[20:23], v3, s[24:27], 0 offen offset:0
  buffer_load_dwordx4 v[24:27], v3, s[24:27], 0 offen offset:256
  buffer_load_dwordx4 v[28:31], v3, s[24:27], 0 offen offset:512
  buffer_load_dwordx4 v[32:35], v3, s[24:27], 0 offen offset:768
  buffer_load_dword v6, v6, s[20:23], 0 offen sc1
  s_mov_b32 s63, s60
  s_mov_b32 m0, 0
  s_nop 0
  buffer_load_dwordx4 v4, s[28:31], s63 offen nt lds
  s_add_u32 s63, s63, 0x10000
  s_mov_b32 m0, 1024
  s_nop 0
  buffer_load_dwordx4 v4, s[28:31], s63 offen nt lds
  s_add_u32 s63, s63, 0x10000
  s_mov_b32 m0, 2048
  s_nop 0
  buffer_load_dwordx4 v4, s[28:31], s63 offen nt lds
  s_add_u32 s63, s63, 0x10000
  s_mov_b32 m0, 3072
  s_nop 0
  buffer_load_dwordx4 v4, s[28:31], s63 offen nt lds
  s_add_u32 s63, s63, 0x10000
  s_mov_b32 m0, 4096
  s_nop 0
  buffer_load_dwordx4 v4, s[28:31], s63 offen nt lds
  s_add_u32 s63, s63, 0x10000
  s_mov_b32 m0, 5120
  s_nop 0
  buffer_load_dwordx4 v4, s[28:31], s63 offen nt lds
  s_add_u32 s63, s63, 0x10000
  s_mov_b32 m0, 6144
  s_nop 0
  buffer_load_dwordx4 v4, s[28:31], s63 offen nt lds
  s_add_u32 s63, s63, 0x10000
  s_mov_b32 m0, 7168
  s_nop 0
  buffer_load_dwordx4 v4, s[28:31], s63 offen nt lds
  s_add_u32 s63, s63, 0x10000
  s_mov_b32 m0, 8192
  s_nop 0
  buffer_load_dwordx4 v4, s[28:31], s63 offen nt lds
  s_add_u32 s63, s63, 0x10000
  s_mov_b32 m0, 9216
  s_nop 0
  buffer_load_dwordx4 v4, s[28:31], s63 offen nt lds
  s_add_u32 s63, s63, 0x10000
  s_mov_b32 m0, 10240
  s_nop 0
  buffer_load_dwordx4 v4, s[28:31], s63 offen nt lds
  s_add_u32 s63, s63, 0x10000
  s_mov_b32 m0, 11264
  s_nop 0
  buffer_load_dwordx4 v4, s[28:31], s63 offen nt lds
  s_add_u32 s63, s63, 0x10000
  s_mov_b32 m0, 12288
  s_nop 0
  buffer_load_dwordx4 v4, s[28:31], s63 offen nt lds
  s_add_u32 s63, s63, 0x10000
  s_mov_b32 m0, 13312
  s_nop 0
  buffer_load_dwordx4 v4, s[28:31], s63 offen nt lds
  s_add_u32 s63, s63, 0x10000
  s_mov_b32 m0, 14336
  s_nop 0
  buffer_load_dwordx4 v4, s[28:31], s63 offen nt lds
  s_add_u32 s63, s63, 0x10000
  s_mov_b32 m0, 15360
  s_nop 0
  buffer_load_dwordx4 v4, s[28:31], s63 offen nt lds
  s_load_dwordx2 s[48:49], s[0:1], 48
  s_load_dwordx2 s[36:37], s[0:1], 56
  s_load_dwordx2 s[50:51], s[0:1], 64
  s_load_dwordx2 s[40:41], s[0:1], 72
  s_load_dwordx2 s[44:45], s[0:1], 80
  s_mov_b32 s38, 0xe00
  s_mov_b32 s39, 0x20000
  s_mov_b32 s42, 0x400
  s_mov_b32 s43, 0x20000
  s_mov_b32 s46, 0x1000
  s_mov_b32 s47, 0x20000
  v_mul_u32_u24 v9, 1088, v2
  v_add_u32 v9, v9, v19
  v_bfe_u32 v17, v0, 2, 2
  v_mul_u32_u24 v8, 1088, v17
  v_lshl_add_u32 v8, v2, 4, v8
  v_lshl_or_b32 v7, v2, 3, v17
  v_lshlrev_b32 v7, 7, v7
  v_and_b32 v16, 3, v0
  v_lshl_or_b32 v38, v16, 5, v7
  v_bfe_u32 v16, v0, 1, 1
  v_lshl_or_b32 v7, v16, 6, v7
  v_and_b32 v16, 1, v0
  v_lshl_or_b32 v7, v16, 3, v7
  s_and_b32 s52, s5, 3
  s_bfe_u32 s53, s5, 0x20002
  s_lshl_b32 s54, s53, 3
  s_add_u32 s54, s54, s4
  s_bfe_u32 s56, s5, 0x10003
  s_lshl_b32 s57, s56, 4
  s_add_u32 s57, s57, s4
  s_lshl_b32 s57, s57, 16
  s_xor_b32 s93, s7, 4
  s_lshl_b32 s58, s93, 7
  s_add_u32 s57, s57, s58
  s_mul_i32 s58, s52, 458752
  s_lshl_b32 s55, s54, 7
  s_add_u32 s58, s58, s55
  s_cmp_lt_u32 s54, 28
  s_cselect_b32 s59, 1, 0
  s_cmp_ge_u32 s5, 16
  s_cselect_b32 s59, 2, s59
  s_cselect_b32 s57, s57, s58
  s_movk_i32 s58, 3584
  s_cselect_b32 s58, 0x400, s58
  s_cselect_b32 s55, 458752, 0
  s_mov_b32 s34, 0x1c0000
  s_mov_b32 s35, 0x20000
  v_mad_u32_u24 v36, v36, s58, v37
  s_lshl_b32 s58, s58, 3
  s_lshl_b32 s62, s6, 10
  s_add_u32 s62, s62, s61
  s_lshl_b32 s63, s6, 8
  v_add_u32 v37, s63, v8
  s_mov_b32 s16, 0x22222222
  s_mov_b32 s17, s16
  s_mov_b32 s18, 0x44444444
  s_mov_b32 s19, s18
  s_mov_b32 s14, 0x88888888
  s_mov_b32 s15, s14
  s_mov_b32 s10, 0x3ff
  s_waitcnt vmcnt(17)
  v_lshlrev_b32 v40, 16, v20
  v_and_b32 v41, 0xffff0000, v20
  v_lshlrev_b32 v42, 16, v21
  v_and_b32 v43, 0xffff0000, v21
  v_lshlrev_b32 v44, 16, v22
  v_and_b32 v45, 0xffff0000, v22
  v_lshlrev_b32 v46, 16, v23
  v_and_b32 v47, 0xffff0000, v23
  v_lshlrev_b32 v48, 16, v24
  v_and_b32 v49, 0xffff0000, v24
  v_lshlrev_b32 v50, 16, v25
  v_and_b32 v51, 0xffff0000, v25
  v_lshlrev_b32 v52, 16, v26
  v_and_b32 v53, 0xffff0000, v26
  v_lshlrev_b32 v54, 16, v27
  v_and_b32 v55, 0xffff0000, v27
  v_lshlrev_b32 v56, 16, v28
  v_and_b32 v57, 0xffff0000, v28
  v_lshlrev_b32 v58, 16, v29
  v_and_b32 v59, 0xffff0000, v29
  v_lshlrev_b32 v60, 16, v30
  v_and_b32 v61, 0xffff0000, v30
  v_lshlrev_b32 v62, 16, v31
  v_and_b32 v63, 0xffff0000, v31
  v_lshlrev_b32 v64, 16, v32
  v_and_b32 v65, 0xffff0000, v32
  v_lshlrev_b32 v66, 16, v33
  v_and_b32 v67, 0xffff0000, v33
  v_lshlrev_b32 v68, 16, v34
  v_and_b32 v69, 0xffff0000, v34
  v_lshlrev_b32 v70, 16, v35
  v_and_b32 v71, 0xffff0000, v35
  v_pk_add_f32 v[16:17], v[40:41], v[42:43]
  v_pk_add_f32 v[16:17], v[16:17], v[44:45]
  v_pk_add_f32 v[16:17], v[16:17], v[46:47]
  v_pk_add_f32 v[16:17], v[16:17], v[48:49]
  v_pk_add_f32 v[16:17], v[16:17], v[50:51]
  v_pk_add_f32 v[16:17], v[16:17], v[52:53]
  v_pk_add_f32 v[16:17], v[16:17], v[54:55]
  v_pk_add_f32 v[16:17], v[16:17], v[56:57]
  v_pk_add_f32 v[16:17], v[16:17], v[58:59]
  v_pk_add_f32 v[16:17], v[16:17], v[60:61]
  v_pk_add_f32 v[16:17], v[16:17], v[62:63]
  v_pk_add_f32 v[16:17], v[16:17], v[64:65]
  v_pk_add_f32 v[16:17], v[16:17], v[66:67]
  v_pk_add_f32 v[16:17], v[16:17], v[68:69]
  v_pk_add_f32 v[16:17], v[16:17], v[70:71]
  v_add_f32 v16, v16, v17
  s_nop 1
  v_add_f32_dpp v16, v16, v16 row_ror:1 row_mask:0xf bank_mask:0xf
  s_nop 1
  v_add_f32_dpp v16, v16, v16 row_ror:2 row_mask:0xf bank_mask:0xf
  s_nop 1
  v_add_f32_dpp v16, v16, v16 row_ror:4 row_mask:0xf bank_mask:0xf
  s_nop 1
  v_add_f32_dpp v16, v16, v16 row_ror:8 row_mask:0xf bank_mask:0xf
  v_mul_f32 v17, 0x3b000000, v16
  v_cvt_pk_bf16_f32 v16, v17, v17
  v_lshlrev_b32 v16, 16, v16
  v_sub_f32 v17, v17, v16
  v_pk_add_f32 v[40:41], v[40:41], v[16:17] op_sel_hi:[1,0] neg_lo:[0,1] neg_hi:[0,1]
  v_pk_add_f32 v[42:43], v[42:43], v[16:17] op_sel_hi:[1,0] neg_lo:[0,1] neg_hi:[0,1]
  v_pk_add_f32 v[44:45], v[44:45], v[16:17] op_sel_hi:[1,0] neg_lo:[0,1] neg_hi:[0,1]
  v_pk_add_f32 v[46:47], v[46:47], v[16:17] op_sel_hi:[1,0] neg_lo:[0,1] neg_hi:[0,1]
  v_pk_add_f32 v[48:49], v[48:49], v[16:17] op_sel_hi:[1,0] neg_lo:[0,1] neg_hi:[0,1]
  v_pk_add_f32 v[50:51], v[50:51], v[16:17] op_sel_hi:[1,0] neg_lo:[0,1] neg_hi:[0,1]
  v_pk_add_f32 v[52:53], v[52:53], v[16:17] op_sel_hi:[1,0] neg_lo:[0,1] neg_hi:[0,1]
  v_pk_add_f32 v[54:55], v[54:55], v[16:17] op_sel_hi:[1,0] neg_lo:[0,1] neg_hi:[0,1]
  v_pk_add_f32 v[56:57], v[56:57], v[16:17] op_sel_hi:[1,0] neg_lo:[0,1] neg_hi:[0,1]
  v_pk_add_f32 v[58:59], v[58:59], v[16:17] op_sel_hi:[1,0] neg_lo:[0,1] neg_hi:[0,1]
  v_pk_add_f32 v[60:61], v[60:61], v[16:17] op_sel_hi:[1,0] neg_lo:[0,1] neg_hi:[0,1]
  v_pk_add_f32 v[62:63], v[62:63], v[16:17] op_sel_hi:[1,0] neg_lo:[0,1] neg_hi:[0,1]
  v_pk_add_f32 v[64:65], v[64:65], v[16:17] op_sel_hi:[1,0] neg_lo:[0,1] neg_hi:[0,1]
  v_pk_add_f32 v[66:67], v[66:67], v[16:17] op_sel_hi:[1,0] neg_lo:[0,1] neg_hi:[0,1]
  v_pk_add_f32 v[68:69], v[68:69], v[16:17] op_sel_hi:[1,0] neg_lo:[0,1] neg_hi:[0,1]
  v_pk_add_f32 v[70:71], v[70:71], v[16:17] op_sel_hi:[1,0] neg_lo:[0,1] neg_hi:[0,1]
  v_pk_mul_f32 v[18:19], v[40:41], v[40:41]
  v_pk_fma_f32 v[18:19], v[42:43], v[42:43], v[18:19]
  v_pk_fma_f32 v[18:19], v[44:45], v[44:45], v[18:19]
  v_pk_fma_f32 v[18:19], v[46:47], v[46:47], v[18:19]
  v_pk_fma_f32 v[18:19], v[48:49], v[48:49], v[18:19]
  v_pk_fma_f32 v[18:19], v[50:51], v[50:51], v[18:19]
  v_pk_fma_f32 v[18:19], v[52:53], v[52:53], v[18:19]
  v_pk_fma_f32 v[18:19], v[54:55], v[54:55], v[18:19]
  v_pk_fma_f32 v[18:19], v[56:57], v[56:57], v[18:19]
  v_pk_fma_f32 v[18:19], v[58:59], v[58:59], v[18:19]
  v_pk_fma_f32 v[18:19], v[60:61], v[60:61], v[18:19]
  v_pk_fma_f32 v[18:19], v[62:63], v[62:63], v[18:19]
  v_pk_fma_f32 v[18:19], v[64:65], v[64:65], v[18:19]
  v_pk_fma_f32 v[18:19], v[66:67], v[66:67], v[18:19]
  v_pk_fma_f32 v[18:19], v[68:69], v[68:69], v[18:19]
  v_pk_fma_f32 v[18:19], v[70:71], v[70:71], v[18:19]
  v_add_f32 v18, v18, v19
  s_nop 1
  v_add_f32_dpp v18, v18, v18 row_ror:1 row_mask:0xf bank_mask:0xf
  s_nop 1
  v_add_f32_dpp v18, v18, v18 row_ror:2 row_mask:0xf bank_mask:0xf
  s_nop 1
  v_add_f32_dpp v18, v18, v18 row_ror:4 row_mask:0xf bank_mask:0xf
  s_nop 1
  v_add_f32_dpp v18, v18, v18 row_ror:8 row_mask:0xf bank_mask:0xf
  v_mul_f32 v17, v17, v17
  v_mov_b32 v19, 0x3b000000
  v_fma_f32 v18, v18, v19, -v17
  v_max_f32 v18, 0, v18
  v_cvt_pk_bf16_f32 v18, v18, v18
  v_lshlrev_b32 v18, 16, v18
  v_add_f32 v18, 0x3727c5ac, v18
  v_cvt_pk_bf16_f32 v18, v18, v18
  v_lshlrev_b32 v18, 16, v18
  v_sqrt_f32 v18, v18
  s_nop 0
  v_cvt_pk_bf16_f32 v18, v18, v18
  v_lshlrev_b32 v18, 16, v18
  v_rcp_f32 v18, v18
  s_nop 0
  v_pk_mul_f32 v[40:41], v[40:41], v[18:19] op_sel_hi:[1,0]
  v_cvt_pk_bf16_f32 v20, v40, v41
  v_pk_mul_f32 v[42:43], v[42:43], v[18:19] op_sel_hi:[1,0]
  v_cvt_pk_bf16_f32 v21, v42, v43
  v_pk_mul_f32 v[44:45], v[44:45], v[18:19] op_sel_hi:[1,0]
  v_cvt_pk_bf16_f32 v22, v44, v45
  v_pk_mul_f32 v[46:47], v[46:47], v[18:19] op_sel_hi:[1,0]
  v_cvt_pk_bf16_f32 v23, v46, v47
  v_pk_mul_f32 v[48:49], v[48:49], v[18:19] op_sel_hi:[1,0]
  v_cvt_pk_bf16_f32 v24, v48, v49
  v_pk_mul_f32 v[50:51], v[50:51], v[18:19] op_sel_hi:[1,0]
  v_cvt_pk_bf16_f32 v25, v50, v51
  v_pk_mul_f32 v[52:53], v[52:53], v[18:19] op_sel_hi:[1,0]
  v_cvt_pk_bf16_f32 v26, v52, v53
  v_pk_mul_f32 v[54:55], v[54:55], v[18:19] op_sel_hi:[1,0]
  v_cvt_pk_bf16_f32 v27, v54, v55
  v_pk_mul_f32 v[56:57], v[56:57], v[18:19] op_sel_hi:[1,0]
  v_cvt_pk_bf16_f32 v28, v56, v57
  v_pk_mul_f32 v[58:59], v[58:59], v[18:19] op_sel_hi:[1,0]
  v_cvt_pk_bf16_f32 v29, v58, v59
  v_pk_mul_f32 v[60:61], v[60:61], v[18:19] op_sel_hi:[1,0]
  v_cvt_pk_bf16_f32 v30, v60, v61
  v_pk_mul_f32 v[62:63], v[62:63], v[18:19] op_sel_hi:[1,0]
  v_cvt_pk_bf16_f32 v31, v62, v63
  v_pk_mul_f32 v[64:65], v[64:65], v[18:19] op_sel_hi:[1,0]
  v_cvt_pk_bf16_f32 v32, v64, v65
  v_pk_mul_f32 v[66:67], v[66:67], v[18:19] op_sel_hi:[1,0]
  v_cvt_pk_bf16_f32 v33, v66, v67
  v_pk_mul_f32 v[68:69], v[68:69], v[18:19] op_sel_hi:[1,0]
  v_cvt_pk_bf16_f32 v34, v68, v69
  v_pk_mul_f32 v[70:71], v[70:71], v[18:19] op_sel_hi:[1,0]
  v_cvt_pk_bf16_f32 v35, v70, v71
  ds_write_b128 v9, v[20:23] offset:32768
  ds_write_b128 v9, v[24:27] offset:33024
  ds_write_b128 v9, v[28:31] offset:33280
  ds_write_b128 v9, v[32:35] offset:33536
  s_waitcnt vmcnt(0)
  v_add_u32 v5, 0x2a5, v6
  v_add_u32 v6, 1, v6
  v_lshrrev_b32 v88, 10, v5
  v_add_u32 v88, v88, v5
  v_lshrrev_b32 v89, 20, v5
  v_add_u32 v89, v89, v5
  v_and_b32 v5, 0x3ff, v5
  v_and_b32 v88, 0x3ff, v88
  v_and_b32 v89, 0x3ff, v89
  s_waitcnt lgkmcnt(0)
  ds_read_b128 v[96:99], v37 offset:32768
  ds_read_b64_tr_b16 v[100:101], v7 offset:0
  ds_read_b64_tr_b16 v[102:103], v7 offset:512
  ds_read_b64_tr_b16 v[104:105], v7 offset:16
  ds_read_b64_tr_b16 v[106:107], v7 offset:528
  ds_read_b64_tr_b16 v[108:109], v7 offset:32
  ds_read_b64_tr_b16 v[110:111], v7 offset:544
  ds_read_b64_tr_b16 v[112:113], v7 offset:48
  ds_read_b64_tr_b16 v[114:115], v7 offset:560
  s_waitcnt lgkmcnt(0)
  ds_read_b128 v[116:119], v37 offset:32832
  ds_read_b64_tr_b16 v[120:121], v7 offset:4096
  ds_read_b64_tr_b16 v[122:123], v7 offset:4608
  ds_read_b64_tr_b16 v[124:125], v7 offset:4112
  ds_read_b64_tr_b16 v[126:127], v7 offset:4624
  ds_read_b64_tr_b16 v[128:129], v7 offset:4128
  ds_read_b64_tr_b16 v[130:131], v7 offset:4640
  ds_read_b64_tr_b16 v[132:133], v7 offset:4144
  ds_read_b64_tr_b16 v[134:135], v7 offset:4656
  v_mfma_f32_16x16x32_bf16 v[72:75], v[100:103], v[96:99], 0
  v_mfma_f32_16x16x32_bf16 v[76:79], v[104:107], v[96:99], 0
  v_mfma_f32_16x16x32_bf16 v[80:83], v[108:111], v[96:99], 0
  v_mfma_f32_16x16x32_bf16 v[84:87], v[112:115], v[96:99], 0
  s_waitcnt lgkmcnt(0)
  ds_read_b128 v[96:99], v37 offset:32896
  ds_read_b64_tr_b16 v[100:101], v7 offset:8192
  ds_read_b64_tr_b16 v[102:103], v7 offset:8704
  ds_read_b64_tr_b16 v[104:105], v7 offset:8208
  ds_read_b64_tr_b16 v[106:107], v7 offset:8720
  ds_read_b64_tr_b16 v[108:109], v7 offset:8224
  ds_read_b64_tr_b16 v[110:111], v7 offset:8736
  ds_read_b64_tr_b16 v[112:113], v7 offset:8240
  ds_read_b64_tr_b16 v[114:115], v7 offset:8752
  v_mfma_f32_16x16x32_bf16 v[72:75], v[120:123], v[116:119], v[72:75]
  v_mfma_f32_16x16x32_bf16 v[76:79], v[124:127], v[116:119], v[76:79]
  v_mfma_f32_16x16x32_bf16 v[80:83], v[128:131], v[116:119], v[80:83]
  v_mfma_f32_16x16x32_bf16 v[84:87], v[132:135], v[116:119], v[84:87]
  s_waitcnt lgkmcnt(0)
  ds_read_b128 v[116:119], v37 offset:32960
  ds_read_b64_tr_b16 v[120:121], v7 offset:12288
  ds_read_b64_tr_b16 v[122:123], v7 offset:12800
  ds_read_b64_tr_b16 v[124:125], v7 offset:12304
  ds_read_b64_tr_b16 v[126:127], v7 offset:12816
  ds_read_b64_tr_b16 v[128:129], v7 offset:12320
  ds_read_b64_tr_b16 v[130:131], v7 offset:12832
  ds_read_b64_tr_b16 v[132:133], v7 offset:12336
  ds_read_b64_tr_b16 v[134:135], v7 offset:12848
  v_mfma_f32_16x16x32_bf16 v[72:75], v[100:103], v[96:99], v[72:75]
  v_mfma_f32_16x16x32_bf16 v[76:79], v[104:107], v[96:99], v[76:79]
  v_mfma_f32_16x16x32_bf16 v[80:83], v[108:111], v[96:99], v[80:83]
  v_mfma_f32_16x16x32_bf16 v[84:87], v[112:115], v[96:99], v[84:87]
  s_waitcnt lgkmcnt(0)
  v_mfma_f32_16x16x32_bf16 v[72:75], v[120:123], v[116:119], v[72:75]
  v_mfma_f32_16x16x32_bf16 v[76:79], v[124:127], v[116:119], v[76:79]
  v_mfma_f32_16x16x32_bf16 v[80:83], v[128:131], v[116:119], v[80:83]
  v_mfma_f32_16x16x32_bf16 v[84:87], v[132:135], v[116:119], v[84:87]
  s_lshl_b32 s60, s6, 16
  s_lshl_b32 s63, s4, 11
  s_add_u32 s60, s60, s63
  s_and_b32 s63, s7, 1
  s_lshl_b32 s63, s63, 7
  s_add_u32 s60, s60, s63
  s_lshr_b32 s63, s7, 1
  s_lshl_b32 s63, s63, 9
  s_add_u32 s60, s60, s63
  s_add_u32 s60, s60, 4096
  v_bfe_u32 v16, v0, 2, 2
  v_and_b32 v17, 3, v0
  v_lshlrev_b32 v4, 14, v16
  v_lshl_or_b32 v4, v17, 4, v4
  v_bfe_u32 v17, v0, 4, 1
  v_lshl_or_b32 v4, v17, 8, v4
  v_bfe_u32 v17, v0, 5, 1
  v_lshl_or_b32 v4, v17, 6, v4
  v_cndmask_b32 v72, v72, v76, s[16:17]
  v_cndmask_b32 v73, v73, v77, s[16:17]
  v_cndmask_b32 v74, v74, v78, s[16:17]
  v_cndmask_b32 v75, v75, v79, s[16:17]
  v_cndmask_b32 v72, v72, v80, s[18:19]
  v_cndmask_b32 v73, v73, v81, s[18:19]
  v_cndmask_b32 v74, v74, v82, s[18:19]
  v_cndmask_b32 v75, v75, v83, s[18:19]
  v_cndmask_b32 v72, v72, v84, s[14:15]
  v_cndmask_b32 v73, v73, v85, s[14:15]
  v_cndmask_b32 v74, v74, v86, s[14:15]
  v_cndmask_b32 v75, v75, v87, s[14:15]
  v_bfi_b32 v72, s10, v5, v72
  v_bfi_b32 v73, s10, v88, v73
  v_bfi_b32 v74, s10, v89, v74
  v_bfi_b32 v75, s10, v5, v75
  s_getreg_b32 s11, hwreg(HW_REG_XCC_ID, 0, 3)
  s_lshl_b32 s11, s11, 10
  v_mov_b32 v16, 0x1c00
  v_bfi_b32 v72, v16, s11, v72
  buffer_store_dwordx4 v[72:75], v4, s[20:23], s60 offen
  s_add_u32 s9, s60, 0x400000
  v_and_b32 v18, 1, v0
  v_lshl_or_b32 v39, v18, 2, v2
  v_lshlrev_b32 v39, 1, v39
  buffer_load_ushort v14, v39, s[24:27], s62 offen
  buffer_load_ushort v15, v39, s[40:43], s61 offen
  s_cmp_eq_u32 s59, 0
  s_cbranch_scc1 L_no_ln2
  s_cmp_ge_u32 s5, 16
  s_cselect_b64 s[32:33], s[50:51], s[48:49]
  s_mov_b32 m0, 16384
  s_nop 0
  buffer_load_dwordx4 v36, s[32:35], s57 offen nt lds
  s_add_u32 s57, s57, s58
  s_mov_b32 m0, 17408
  s_nop 0
  buffer_load_dwordx4 v36, s[32:35], s57 offen nt lds
  s_add_u32 s57, s57, s58
  s_mov_b32 m0, 18432
  s_nop 0
  buffer_load_dwordx4 v36, s[32:35], s57 offen nt lds
  s_add_u32 s57, s57, s58
  s_mov_b32 m0, 19456
  s_nop 0
  buffer_load_dwordx4 v36, s[32:35], s57 offen nt lds
  s_add_u32 s57, s57, s58
  s_mov_b32 m0, 20480
  s_nop 0
  buffer_load_dwordx4 v36, s[32:35], s57 offen nt lds
  s_add_u32 s57, s57, s58
  s_mov_b32 m0, 21504
  s_nop 0
  buffer_load_dwordx4 v36, s[32:35], s57 offen nt lds
  s_add_u32 s57, s57, s58
  s_mov_b32 m0, 22528
  s_nop 0
  buffer_load_dwordx4 v36, s[32:35], s57 offen nt lds
  s_add_u32 s57, s57, s58
  s_mov_b32 m0, 23552
  s_nop 0
  buffer_load_dwordx4 v36, s[32:35], s57 offen nt lds
  s_add_u32 s57, s57, s58
  s_add_u32 s57, s57, s55
  s_mov_b32 m0, 24576
  s_nop 0
  buffer_load_dwordx4 v36, s[32:35], s57 offen nt lds
  s_add_u32 s57, s57, s58
  s_mov_b32 m0, 25600
  s_nop 0
  buffer_load_dwordx4 v36, s[32:35], s57 offen nt lds
  s_add_u32 s57, s57, s58
  s_mov_b32 m0, 26624
  s_nop 0
  buffer_load_dwordx4 v36, s[32:35], s57 offen nt lds
  s_add_u32 s57, s57, s58
  s_mov_b32 m0, 27648
  s_nop 0
  buffer_load_dwordx4 v36, s[32:35], s57 offen nt lds
  s_add_u32 s57, s57, s58
  s_mov_b32 m0, 28672
  s_nop 0
  buffer_load_dwordx4 v36, s[32:35], s57 offen nt lds
  s_add_u32 s57, s57, s58
  s_mov_b32 m0, 29696
  s_nop 0
  buffer_load_dwordx4 v36, s[32:35], s57 offen nt lds
  s_add_u32 s57, s57, s58
  s_mov_b32 m0, 30720
  s_nop 0
  buffer_load_dwordx4 v36, s[32:35], s57 offen nt lds
  s_add_u32 s57, s57, s58
  s_mov_b32 m0, 31744
  s_nop 0
  buffer_load_dwordx4 v36, s[32:35], s57 offen nt lds
  s_cmp_lg_u32 s59, 1
  s_cbranch_scc1 L_no_ln2
  v_lshlrev_b32 v40, 16, v20
  v_and_b32 v41, 0xffff0000, v20
  v_lshlrev_b32 v42, 16, v21
  v_and_b32 v43, 0xffff0000, v21
  v_lshlrev_b32 v44, 16, v22
  v_and_b32 v45, 0xffff0000, v22
  v_lshlrev_b32 v46, 16, v23
  v_and_b32 v47, 0xffff0000, v23
  v_lshlrev_b32 v48, 16, v24
  v_and_b32 v49, 0xffff0000, v24
  v_lshlrev_b32 v50, 16, v25
  v_and_b32 v51, 0xffff0000, v25
  v_lshlrev_b32 v52, 16, v26
  v_and_b32 v53, 0xffff0000, v26
  v_lshlrev_b32 v54, 16, v27
  v_and_b32 v55, 0xffff0000, v27
  v_lshlrev_b32 v56, 16, v28
  v_and_b32 v57, 0xffff0000, v28
  v_lshlrev_b32 v58, 16, v29
  v_and_b32 v59, 0xffff0000, v29
  v_lshlrev_b32 v60, 16, v30
  v_and_b32 v61, 0xffff0000, v30
  v_lshlrev_b32 v62, 16, v31
  v_and_b32 v63, 0xffff0000, v31
  v_lshlrev_b32 v64, 16, v32
  v_and_b32 v65, 0xffff0000, v32
  v_lshlrev_b32 v66, 16, v33
  v_and_b32 v67, 0xffff0000, v33
  v_lshlrev_b32 v68, 16, v34
  v_and_b32 v69, 0xffff0000, v34
  v_lshlrev_b32 v70, 16, v35
  v_and_b32 v71, 0xffff0000, v35
  v_pk_add_f32 v[16:17], v[40:41], v[42:43]
  v_pk_add_f32 v[16:17], v[16:17], v[44:45]
  v_pk_add_f32 v[16:17], v[16:17], v[46:47]
  v_pk_add_f32 v[16:17], v[16:17], v[48:49]
  v_pk_add_f32 v[16:17], v[16:17], v[50:51]
  v_pk_add_f32 v[16:17], v[16:17], v[52:53]
  v_pk_add_f32 v[16:17], v[16:17], v[54:55]
  v_pk_add_f32 v[16:17], v[16:17], v[56:57]
  v_pk_add_f32 v[16:17], v[16:17], v[58:59]
  v_pk_add_f32 v[16:17], v[16:17], v[60:61]
  v_pk_add_f32 v[16:17], v[16:17], v[62:63]
  v_pk_add_f32 v[16:17], v[16:17], v[64:65]
  v_pk_add_f32 v[16:17], v[16:17], v[66:67]
  v_pk_add_f32 v[16:17], v[16:17], v[68:69]
  v_pk_add_f32 v[16:17], v[16:17], v[70:71]
  v_add_f32 v16, v16, v17
  s_nop 1
  v_add_f32_dpp v16, v16, v16 row_ror:1 row_mask:0xf bank_mask:0xf
  s_nop 1
  v_add_f32_dpp v16, v16, v16 row_ror:2 row_mask:0xf bank_mask:0xf
  s_nop 1
  v_add_f32_dpp v16, v16, v16 row_ror:4 row_mask:0xf bank_mask:0xf
  s_nop 1
  v_add_f32_dpp v16, v16, v16 row_ror:8 row_mask:0xf bank_mask:0xf
  v_mul_f32 v17, 0x3b000000, v16
  v_cvt_pk_bf16_f32 v16, v17, v17
  v_lshlrev_b32 v16, 16, v16
  v_sub_f32 v17, v17, v16
  v_pk_add_f32 v[40:41], v[40:41], v[16:17] op_sel_hi:[1,0] neg_lo:[0,1] neg_hi:[0,1]
  v_pk_add_f32 v[42:43], v[42:43], v[16:17] op_sel_hi:[1,0] neg_lo:[0,1] neg_hi:[0,1]
  v_pk_add_f32 v[44:45], v[44:45], v[16:17] op_sel_hi:[1,0] neg_lo:[0,1] neg_hi:[0,1]
  v_pk_add_f32 v[46:47], v[46:47], v[16:17] op_sel_hi:[1,0] neg_lo:[0,1] neg_hi:[0,1]
  v_pk_add_f32 v[48:49], v[48:49], v[16:17] op_sel_hi:[1,0] neg_lo:[0,1] neg_hi:[0,1]
  v_pk_add_f32 v[50:51], v[50:51], v[16:17] op_sel_hi:[1,0] neg_lo:[0,1] neg_hi:[0,1]
  v_pk_add_f32 v[52:53], v[52:53], v[16:17] op_sel_hi:[1,0] neg_lo:[0,1] neg_hi:[0,1]
  v_pk_add_f32 v[54:55], v[54:55], v[16:17] op_sel_hi:[1,0] neg_lo:[0,1] neg_hi:[0,1]
  v_pk_add_f32 v[56:57], v[56:57], v[16:17] op_sel_hi:[1,0] neg_lo:[0,1] neg_hi:[0,1]
  v_pk_add_f32 v[58:59], v[58:59], v[16:17] op_sel_hi:[1,0] neg_lo:[0,1] neg_hi:[0,1]
  v_pk_add_f32 v[60:61], v[60:61], v[16:17] op_sel_hi:[1,0] neg_lo:[0,1] neg_hi:[0,1]
  v_pk_add_f32 v[62:63], v[62:63], v[16:17] op_sel_hi:[1,0] neg_lo:[0,1] neg_hi:[0,1]
  v_pk_add_f32 v[64:65], v[64:65], v[16:17] op_sel_hi:[1,0] neg_lo:[0,1] neg_hi:[0,1]
  v_pk_add_f32 v[66:67], v[66:67], v[16:17] op_sel_hi:[1,0] neg_lo:[0,1] neg_hi:[0,1]
  v_pk_add_f32 v[68:69], v[68:69], v[16:17] op_sel_hi:[1,0] neg_lo:[0,1] neg_hi:[0,1]
  v_pk_add_f32 v[70:71], v[70:71], v[16:17] op_sel_hi:[1,0] neg_lo:[0,1] neg_hi:[0,1]
  v_pk_mul_f32 v[18:19], v[40:41], v[40:41]
  v_pk_fma_f32 v[18:19], v[42:43], v[42:43], v[18:19]
  v_pk_fma_f32 v[18:19], v[44:45], v[44:45], v[18:19]
  v_pk_fma_f32 v[18:19], v[46:47], v[46:47], v[18:19]
  v_pk_fma_f32 v[18:19], v[48:49], v[48:49], v[18:19]
  v_pk_fma_f32 v[18:19], v[50:51], v[50:51], v[18:19]
  v_pk_fma_f32 v[18:19], v[52:53], v[52:53], v[18:19]
  v_pk_fma_f32 v[18:19], v[54:55], v[54:55], v[18:19]
  v_pk_fma_f32 v[18:19], v[56:57], v[56:57], v[18:19]
  v_pk_fma_f32 v[18:19], v[58:59], v[58:59], v[18:19]
  v_pk_fma_f32 v[18:19], v[60:61], v[60:61], v[18:19]
  v_pk_fma_f32 v[18:19], v[62:63], v[62:63], v[18:19]
  v_pk_fma_f32 v[18:19], v[64:65], v[64:65], v[18:19]
  v_pk_fma_f32 v[18:19], v[66:67], v[66:67], v[18:19]
  v_pk_fma_f32 v[18:19], v[68:69], v[68:69], v[18:19]
  v_pk_fma_f32 v[18:19], v[70:71], v[70:71], v[18:19]
  v_add_f32 v18, v18, v19
  s_nop 1
  v_add_f32_dpp v18, v18, v18 row_ror:1 row_mask:0xf bank_mask:0xf
  s_nop 1
  v_add_f32_dpp v18, v18, v18 row_ror:2 row_mask:0xf bank_mask:0xf
  s_nop 1
  v_add_f32_dpp v18, v18, v18 row_ror:4 row_mask:0xf bank_mask:0xf
  s_nop 1
  v_add_f32_dpp v18, v18, v18 row_ror:8 row_mask:0xf bank_mask:0xf
  v_mul_f32 v17, v17, v17
  v_mov_b32 v19, 0x3b000000
  v_fma_f32 v18, v18, v19, -v17
  v_max_f32 v18, 0, v18
  v_cvt_pk_bf16_f32 v18, v18, v18
  v_lshlrev_b32 v18, 16, v18
  v_add_f32 v18, 0x3727c5ac, v18
  v_cvt_pk_bf16_f32 v18, v18, v18
  v_lshlrev_b32 v18, 16, v18
  v_sqrt_f32 v18, v18
  s_nop 0
  v_cvt_pk_bf16_f32 v18, v18, v18
  v_lshlrev_b32 v18, 16, v18
  v_rcp_f32 v18, v18
  s_nop 0
  v_pk_mul_f32 v[40:41], v[40:41], v[18:19] op_sel_hi:[1,0]
  v_cvt_pk_bf16_f32 v20, v40, v41
  v_pk_mul_f32 v[42:43], v[42:43], v[18:19] op_sel_hi:[1,0]
  v_cvt_pk_bf16_f32 v21, v42, v43
  v_pk_mul_f32 v[44:45], v[44:45], v[18:19] op_sel_hi:[1,0]
  v_cvt_pk_bf16_f32 v22, v44, v45
  v_pk_mul_f32 v[46:47], v[46:47], v[18:19] op_sel_hi:[1,0]
  v_cvt_pk_bf16_f32 v23, v46, v47
  v_pk_mul_f32 v[48:49], v[48:49], v[18:19] op_sel_hi:[1,0]
  v_cvt_pk_bf16_f32 v24, v48, v49
  v_pk_mul_f32 v[50:51], v[50:51], v[18:19] op_sel_hi:[1,0]
  v_cvt_pk_bf16_f32 v25, v50, v51
  v_pk_mul_f32 v[52:53], v[52:53], v[18:19] op_sel_hi:[1,0]
  v_cvt_pk_bf16_f32 v26, v52, v53
  v_pk_mul_f32 v[54:55], v[54:55], v[18:19] op_sel_hi:[1,0]
  v_cvt_pk_bf16_f32 v27, v54, v55
  v_pk_mul_f32 v[56:57], v[56:57], v[18:19] op_sel_hi:[1,0]
  v_cvt_pk_bf16_f32 v28, v56, v57
  v_pk_mul_f32 v[58:59], v[58:59], v[18:19] op_sel_hi:[1,0]
  v_cvt_pk_bf16_f32 v29, v58, v59
  v_pk_mul_f32 v[60:61], v[60:61], v[18:19] op_sel_hi:[1,0]
  v_cvt_pk_bf16_f32 v30, v60, v61
  v_pk_mul_f32 v[62:63], v[62:63], v[18:19] op_sel_hi:[1,0]
  v_cvt_pk_bf16_f32 v31, v62, v63
  v_pk_mul_f32 v[64:65], v[64:65], v[18:19] op_sel_hi:[1,0]
  v_cvt_pk_bf16_f32 v32, v64, v65
  v_pk_mul_f32 v[66:67], v[66:67], v[18:19] op_sel_hi:[1,0]
  v_cvt_pk_bf16_f32 v33, v66, v67
  v_pk_mul_f32 v[68:69], v[68:69], v[18:19] op_sel_hi:[1,0]
  v_cvt_pk_bf16_f32 v34, v68, v69
  v_pk_mul_f32 v[70:71], v[70:71], v[18:19] op_sel_hi:[1,0]
  v_cvt_pk_bf16_f32 v35, v70, v71
  ds_write_b128 v9, v[20:23] offset:37120
  ds_write_b128 v9, v[24:27] offset:37376
  ds_write_b128 v9, v[28:31] offset:37632
  ds_write_b128 v9, v[32:35] offset:37888
L_no_ln2:
  v_bfe_u32 v16, v0, 2, 2
  v_and_b32 v17, 3, v0
  v_lshlrev_b32 v3, 4, v17
  v_lshl_or_b32 v3, v2, 6, v3
  v_lshl_or_b32 v3, v16, 9, v3
  s_lshl_b32 s60, s6, 3
  s_add_u32 s60, s60, s4
  s_lshl_b32 s60, s60, 11
  s_add_u32 s96, s60, 4096
  s_add_u32 s97, s60, 69632
  s_add_u32 s98, s60, 135168
  s_add_u32 s99, s60, 200704
  buffer_load_dwordx4 v[96:99], v3, s[20:23], s96 offen sc1
  buffer_load_dwordx4 v[100:103], v3, s[20:23], s96 offen offset:256 sc1
  buffer_load_dwordx4 v[104:107], v3, s[20:23], s97 offen sc1
  buffer_load_dwordx4 v[108:111], v3, s[20:23], s97 offen offset:256 sc1
  buffer_load_dwordx4 v[112:115], v3, s[20:23], s98 offen sc1
  buffer_load_dwordx4 v[116:119], v3, s[20:23], s98 offen offset:256 sc1
  buffer_load_dwordx4 v[120:123], v3, s[20:23], s99 offen sc1
  buffer_load_dwordx4 v[124:127], v3, s[20:23], s99 offen offset:256 sc1
  s_mov_b32 s94, 1048576
L_poll3:
  s_waitcnt vmcnt(0)
  v_xor_b32 v96, v5, v96
  v_xor_b32 v97, v88, v97
  v_xor_b32 v98, v89, v98
  v_xor_b32 v99, v5, v99
  v_xor_b32 v100, v5, v100
  v_xor_b32 v101, v88, v101
  v_xor_b32 v102, v89, v102
  v_xor_b32 v103, v5, v103
  v_xor_b32 v104, v5, v104
  v_xor_b32 v105, v88, v105
  v_xor_b32 v106, v89, v106
  v_xor_b32 v107, v5, v107
  v_xor_b32 v108, v5, v108
  v_xor_b32 v109, v88, v109
  v_xor_b32 v110, v89, v110
  v_xor_b32 v111, v5, v111
  v_xor_b32 v112, v5, v112
  v_xor_b32 v113, v88, v113
  v_xor_b32 v114, v89, v114
  v_xor_b32 v115, v5, v115
  v_xor_b32 v116, v5, v116
  v_xor_b32 v117, v88, v117
  v_xor_b32 v118, v89, v118
  v_xor_b32 v119, v5, v119
  v_xor_b32 v120, v5, v120
  v_xor_b32 v121, v88, v121
  v_xor_b32 v122, v89, v122
  v_xor_b32 v123, v5, v123
  v_xor_b32 v124, v5, v124
  v_xor_b32 v125, v88, v125
  v_xor_b32 v126, v89, v126
  v_xor_b32 v127, v5, v127
  v_or3_b32 v16, v96, v97, v98
  v_or3_b32 v16, v16, v99, v100
  v_or3_b32 v16, v16, v101, v102
  v_or3_b32 v16, v16, v103, v104
  v_or3_b32 v16, v16, v105, v106
  v_or3_b32 v16, v16, v107, v108
  v_or3_b32 v16, v16, v109, v110
  v_or3_b32 v16, v16, v111, v112
  v_or3_b32 v16, v16, v113, v114
  v_or3_b32 v16, v16, v115, v116
  v_or3_b32 v16, v16, v117, v118
  v_or3_b32 v16, v16, v119, v120
  v_or3_b32 v16, v16, v121, v122
  v_or3_b32 v16, v16, v123, v124
  v_or3_b32 v16, v16, v125, v126
  v_bitop3_b32 v16, v16, v127, s10 bitop3:0xa8
  v_cmp_ne_u32 vcc, 0, v16
  s_cbranch_vccz L_poll3_done
  s_sleep 4
  s_and_b32 s95, s94, 15
  s_cmp_eq_u32 s95, 2
  s_cselect_b32 s95, 0x400000, 0
  s_cbranch_scc0 L_poll3_na
  s_mov_b64 exec, -1
  buffer_store_dwordx4 v[72:75], v4, s[20:23], s9 offen sc1
L_poll3_na:
  s_andn2_b32 s96, s96, 0x400000
  s_or_b32 s96, s96, s95
  s_andn2_b32 s97, s97, 0x400000
  s_or_b32 s97, s97, s95
  s_andn2_b32 s98, s98, 0x400000
  s_or_b32 s98, s98, s95
  s_andn2_b32 s99, s99, 0x400000
  s_or_b32 s99, s99, s95
  s_mov_b64 exec, vcc
  buffer_load_dwordx4 v[96:99], v3, s[20:23], s96 offen sc1
  buffer_load_dwordx4 v[100:103], v3, s[20:23], s96 offen offset:256 sc1
  buffer_load_dwordx4 v[104:107], v3, s[20:23], s97 offen sc1
  buffer_load_dwordx4 v[108:111], v3, s[20:23], s97 offen offset:256 sc1
  buffer_load_dwordx4 v[112:115], v3, s[20:23], s98 offen sc1
  buffer_load_dwordx4 v[116:119], v3, s[20:23], s98 offen offset:256 sc1
  buffer_load_dwordx4 v[120:123], v3, s[20:23], s99 offen sc1
  buffer_load_dwordx4 v[124:127], v3, s[20:23], s99 offen offset:256 sc1
  s_sub_u32 s94, s94, 1
  s_cbranch_scc0 L_poll3
  s_waitcnt vmcnt(0)
L_poll3_done:
  s_mov_b64 exec, -1
  v_xor_b32 v16, s11, v96
  v_bitop3_b32 v16, v16, v100, s11 bitop3:0xf6
  v_bitop3_b32 v16, v16, v104, s11 bitop3:0xf6
  v_bitop3_b32 v16, v16, v108, s11 bitop3:0xf6
  v_bitop3_b32 v16, v16, v112, s11 bitop3:0xf6
  v_bitop3_b32 v16, v16, v116, s11 bitop3:0xf6
  v_bitop3_b32 v16, v16, v120, s11 bitop3:0xf6
  v_bitop3_b32 v16, v16, v124, s11 bitop3:0xf6
  v_and_b32 v16, 0x1c00, v16
  v_cmp_ne_u32 s[12:13], 0, v16
  s_nop 0
  s_cmp_eq_u64 s[12:13], 0
  s_cbranch_scc1 L_q_local
  buffer_store_dwordx4 v[72:75], v4, s[20:23], s9 offen sc1
L_q_local:
  v_and_b32 v96, 0xffffe3ff, v96
  v_and_b32 v100, 0xffffe3ff, v100
  v_and_b32 v104, 0xffffe3ff, v104
  v_and_b32 v108, 0xffffe3ff, v108
  v_and_b32 v112, 0xffffe3ff, v112
  v_and_b32 v116, 0xffffe3ff, v116
  v_and_b32 v120, 0xffffe3ff, v120
  v_and_b32 v124, 0xffffe3ff, v124
  v_pk_add_f32 v[96:97], v[96:97], v[104:105]
  v_pk_add_f32 v[98:99], v[98:99], v[106:107]
  v_pk_add_f32 v[100:101], v[100:101], v[108:109]
  v_pk_add_f32 v[102:103], v[102:103], v[110:111]
  v_pk_add_f32 v[96:97], v[96:97], v[112:113]
  v_pk_add_f32 v[98:99], v[98:99], v[114:115]
  v_pk_add_f32 v[100:101], v[100:101], v[116:117]
  v_pk_add_f32 v[102:103], v[102:103], v[118:119]
  v_pk_add_f32 v[96:97], v[96:97], v[120:121]
  v_pk_add_f32 v[98:99], v[98:99], v[122:123]
  v_pk_add_f32 v[100:101], v[100:101], v[124:125]
  v_pk_add_f32 v[102:103], v[102:103], v[126:127]
  v_cvt_pk_bf16_f32 v104, v96, v97
  v_cvt_pk_bf16_f32 v105, v98, v99
  v_cvt_pk_bf16_f32 v106, v100, v101
  v_cvt_pk_bf16_f32 v107, v102, v103
  v_mov_b32 v17, 0
  v_lshlrev_b32 v3, 4, v0
  ds_write_b128 v3, v[104:107] offset:41472
  ds_write_b32 v17, v5 offset:42496
  s_or_b32 s8, s12, s13
  v_mov_b32 v16, s8
  ds_write_b32 v17, v16 offset:42500
  ds_write_b32 v17, v17 offset:42560
  ds_write_b32 v17, v17 offset:42568
  s_waitcnt lgkmcnt(0)
  s_barrier
  s_cmp_lg_u32 s59, 1
  s_cbranch_scc1 L_not_m1
  s_lshl_b32 s63, s52, 8
  v_add_u32 v37, s63, v8
  s_lshl_b32 s60, s4, 4
  s_add_u32 s60, s60, s5
  s_lshl_b32 s60, s60, 10
  s_add_u32 s60, s60, 266240
  ds_read_b128 v[96:99], v37 offset:37120
  ds_read_b64_tr_b16 v[100:101], v38 offset:16384
  ds_read_b64_tr_b16 v[102:103], v38 offset:16896
  ds_read_b64_tr_b16 v[104:105], v38 offset:16392
  ds_read_b64_tr_b16 v[106:107], v38 offset:16904
  ds_read_b64_tr_b16 v[108:109], v38 offset:16400
  ds_read_b64_tr_b16 v[110:111], v38 offset:16912
  ds_read_b64_tr_b16 v[112:113], v38 offset:16408
  ds_read_b64_tr_b16 v[114:115], v38 offset:16920
  s_waitcnt lgkmcnt(0)
  ds_read_b128 v[116:119], v37 offset:37184
  ds_read_b64_tr_b16 v[120:121], v38 offset:20480
  ds_read_b64_tr_b16 v[122:123], v38 offset:20992
  ds_read_b64_tr_b16 v[124:125], v38 offset:20488
  ds_read_b64_tr_b16 v[126:127], v38 offset:21000
  ds_read_b64_tr_b16 v[128:129], v38 offset:20496
  ds_read_b64_tr_b16 v[130:131], v38 offset:21008
  ds_read_b64_tr_b16 v[132:133], v38 offset:20504
  ds_read_b64_tr_b16 v[134:135], v38 offset:21016
  v_mfma_f32_16x16x32_bf16 v[72:75], v[100:103], v[96:99], 0
  v_mfma_f32_16x16x32_bf16 v[76:79], v[104:107], v[96:99], 0
  v_mfma_f32_16x16x32_bf16 v[80:83], v[108:111], v[96:99], 0
  v_mfma_f32_16x16x32_bf16 v[84:87], v[112:115], v[96:99], 0
  s_waitcnt lgkmcnt(0)
  ds_read_b128 v[96:99], v37 offset:37248
  ds_read_b64_tr_b16 v[100:101], v38 offset:24576
  ds_read_b64_tr_b16 v[102:103], v38 offset:25088
  ds_read_b64_tr_b16 v[104:105], v38 offset:24584
  ds_read_b64_tr_b16 v[106:107], v38 offset:25096
  ds_read_b64_tr_b16 v[108:109], v38 offset:24592
  ds_read_b64_tr_b16 v[110:111], v38 offset:25104
  ds_read_b64_tr_b16 v[112:113], v38 offset:24600
  ds_read_b64_tr_b16 v[114:115], v38 offset:25112
  v_mfma_f32_16x16x32_bf16 v[72:75], v[120:123], v[116:119], v[72:75]
  v_mfma_f32_16x16x32_bf16 v[76:79], v[124:127], v[116:119], v[76:79]
  v_mfma_f32_16x16x32_bf16 v[80:83], v[128:131], v[116:119], v[80:83]
  v_mfma_f32_16x16x32_bf16 v[84:87], v[132:135], v[116:119], v[84:87]
  s_waitcnt lgkmcnt(0)
  ds_read_b128 v[116:119], v37 offset:37312
  ds_read_b64_tr_b16 v[120:121], v38 offset:28672
  ds_read_b64_tr_b16 v[122:123], v38 offset:29184
  ds_read_b64_tr_b16 v[124:125], v38 offset:28680
  ds_read_b64_tr_b16 v[126:127], v38 offset:29192
  ds_read_b64_tr_b16 v[128:129], v38 offset:28688
  ds_read_b64_tr_b16 v[130:131], v38 offset:29200
  ds_read_b64_tr_b16 v[132:133], v38 offset:28696
  ds_read_b64_tr_b16 v[134:135], v38 offset:29208
  v_mfma_f32_16x16x32_bf16 v[72:75], v[100:103], v[96:99], v[72:75]
  v_mfma_f32_16x16x32_bf16 v[76:79], v[104:107], v[96:99], v[76:79]
  v_mfma_f32_16x16x32_bf16 v[80:83], v[108:111], v[96:99], v[80:83]
  v_mfma_f32_16x16x32_bf16 v[84:87], v[112:115], v[96:99], v[84:87]
  s_waitcnt lgkmcnt(0)
  v_mfma_f32_16x16x32_bf16 v[72:75], v[120:123], v[116:119], v[72:75]
  v_mfma_f32_16x16x32_bf16 v[76:79], v[124:127], v[116:119], v[76:79]
  v_mfma_f32_16x16x32_bf16 v[80:83], v[128:131], v[116:119], v[80:83]
  v_mfma_f32_16x16x32_bf16 v[84:87], v[132:135], v[116:119], v[84:87]
  v_bfe_u32 v16, v0, 2, 2
  v_and_b32 v17, 3, v0
  v_mul_u32_u24 v16, 256, v16
  v_lshl_or_b32 v17, v2, 2, v17
  v_lshl_add_u32 v4, v17, 4, v16
  s_nop 0
  v_cndmask_b32 v72, v72, v76, s[16:17]
  v_cndmask_b32 v73, v73, v77, s[16:17]
  v_cndmask_b32 v74, v74, v78, s[16:17]
  v_cndmask_b32 v75, v75, v79, s[16:17]
  v_cndmask_b32 v72, v72, v80, s[18:19]
  v_cndmask_b32 v73, v73, v81, s[18:19]
  v_cndmask_b32 v74, v74, v82, s[18:19]
  v_cndmask_b32 v75, v75, v83, s[18:19]
  v_cndmask_b32 v72, v72, v84, s[14:15]
  v_cndmask_b32 v73, v73, v85, s[14:15]
  v_cndmask_b32 v74, v74, v86, s[14:15]
  v_cndmask_b32 v75, v75, v87, s[14:15]
  v_bfi_b32 v72, s10, v5, v72
  v_bfi_b32 v73, s10, v5, v73
  v_bfi_b32 v74, s10, v5, v74
  v_bfi_b32 v75, s10, v5, v75
  s_cmp_eq_u64 s[12:13], 0
  s_cbranch_scc0 L_far4
  buffer_store_dwordx4 v[72:75], v4, s[20:23], s60 offen
L_near4:
L_not_m1:
  s_cmp_lg_u32 s59, 2
  s_cbranch_scc1 L_no_m2
  v_lshlrev_b32 v18, 3, v1
  s_lshl_b32 s63, s56, 4
  s_add_u32 s63, s63, s4
  s_lshl_b32 s52, s63, 7
  buffer_load_dwordx2 v[10:11], v18, s[36:39], s52 offen
  buffer_load_dwordx2 v[12:13], v18, s[36:39], s52 offen offset:1024
  v_lshlrev_b32 v3, 4, v0
  v_mul_u32_u24 v16, 1088, v2
  v_add_u32 v4, v16, v18
  s_lshl_b32 s60, s4, 14
  s_lshl_b32 s52, s56, 13
  s_add_u32 s60, s60, s52
  s_add_u32 s96, s60, 266240
  s_cmp_lt_u32 s63, 20
  s_cselect_b32 s52, 0x1000, 0
  s_add_u32 s97, s96, s52
  v_mov_b32 v17, 0
L_lds5:
  s_sleep 4
  ds_read_b32 v16, v17 offset:42560
  s_waitcnt lgkmcnt(0)
  v_cmp_gt_u32 vcc, 1, v16
  s_cbranch_vccnz L_lds5
  buffer_load_dwordx4 v[96:99], v3, s[20:23], s96 offen offset:0 sc1
  buffer_load_dwordx4 v[100:103], v3, s[20:23], s97 offen offset:0 sc1
  buffer_load_dwordx4 v[104:107], v3, s[20:23], s96 offen offset:1024 sc1
  buffer_load_dwordx4 v[108:111], v3, s[20:23], s97 offen offset:1024 sc1
  buffer_load_dwordx4 v[112:115], v3, s[20:23], s96 offen offset:2048 sc1
  buffer_load_dwordx4 v[116:119], v3, s[20:23], s97 offen offset:2048 sc1
  buffer_load_dwordx4 v[120:123], v3, s[20:23], s96 offen offset:3072 sc1
  buffer_load_dwordx4 v[124:127], v3, s[20:23], s97 offen offset:3072 sc1
  s_mov_b32 s94, 1048576
L_poll6:
  s_waitcnt vmcnt(0)
  v_xor_b32 v96, v5, v96
  v_xor_b32 v97, v5, v97
  v_xor_b32 v98, v5, v98
  v_xor_b32 v99, v5, v99
  v_xor_b32 v100, v5, v100
  v_xor_b32 v101, v5, v101
  v_xor_b32 v102, v5, v102
  v_xor_b32 v103, v5, v103
  v_xor_b32 v104, v5, v104
  v_xor_b32 v105, v5, v105
  v_xor_b32 v106, v5, v106
  v_xor_b32 v107, v5, v107
  v_xor_b32 v108, v5, v108
  v_xor_b32 v109, v5, v109
  v_xor_b32 v110, v5, v110
  v_xor_b32 v111, v5, v111
  v_xor_b32 v112, v5, v112
  v_xor_b32 v113, v5, v113
  v_xor_b32 v114, v5, v114
  v_xor_b32 v115, v5, v115
  v_xor_b32 v116, v5, v116
  v_xor_b32 v117, v5, v117
  v_xor_b32 v118, v5, v118
  v_xor_b32 v119, v5, v119
  v_xor_b32 v120, v5, v120
  v_xor_b32 v121, v5, v121
  v_xor_b32 v122, v5, v122
  v_xor_b32 v123, v5, v123
  v_xor_b32 v124, v5, v124
  v_xor_b32 v125, v5, v125
  v_xor_b32 v126, v5, v126
  v_xor_b32 v127, v5, v127
  v_or3_b32 v16, v96, v97, v98
  v_or3_b32 v16, v16, v99, v100
  v_or3_b32 v16, v16, v101, v102
  v_or3_b32 v16, v16, v103, v104
  v_or3_b32 v16, v16, v105, v106
  v_or3_b32 v16, v16, v107, v108
  v_or3_b32 v16, v16, v109, v110
  v_or3_b32 v16, v16, v111, v112
  v_or3_b32 v16, v16, v113, v114
  v_or3_b32 v16, v16, v115, v116
  v_or3_b32 v16, v16, v117, v118
  v_or3_b32 v16, v16, v119, v120
  v_or3_b32 v16, v16, v121, v122
  v_or3_b32 v16, v16, v123, v124
  v_or3_b32 v16, v16, v125, v126
  v_bitop3_b32 v16, v16, v127, s10 bitop3:0xa8
  v_cmp_ne_u32 vcc, 0, v16
  s_cbranch_vccz L_poll6_done
  s_sleep 8
  s_mov_b64 exec, vcc
  buffer_load_dwordx4 v[96:99], v3, s[20:23], s96 offen offset:0 sc1
  buffer_load_dwordx4 v[100:103], v3, s[20:23], s97 offen offset:0 sc1
  buffer_load_dwordx4 v[104:107], v3, s[20:23], s96 offen offset:1024 sc1
  buffer_load_dwordx4 v[108:111], v3, s[20:23], s97 offen offset:1024 sc1
  buffer_load_dwordx4 v[112:115], v3, s[20:23], s96 offen offset:2048 sc1
  buffer_load_dwordx4 v[116:119], v3, s[20:23], s97 offen offset:2048 sc1
  buffer_load_dwordx4 v[120:123], v3, s[20:23], s96 offen offset:3072 sc1
  buffer_load_dwordx4 v[124:127], v3, s[20:23], s97 offen offset:3072 sc1
  s_sub_u32 s94, s94, 1
  s_cbranch_scc0 L_poll6
  s_waitcnt vmcnt(0)
L_poll6_done:
  s_mov_b64 exec, -1
  v_pk_add_f32 v[96:97], v[96:97], v[104:105]
  v_pk_add_f32 v[98:99], v[98:99], v[106:107]
  v_pk_add_f32 v[100:101], v[100:101], v[108:109]
  v_pk_add_f32 v[102:103], v[102:103], v[110:111]
  v_pk_add_f32 v[96:97], v[96:97], v[112:113]
  v_pk_add_f32 v[98:99], v[98:99], v[114:115]
  v_pk_add_f32 v[100:101], v[100:101], v[116:117]
  v_pk_add_f32 v[102:103], v[102:103], v[118:119]
  v_pk_add_f32 v[96:97], v[96:97], v[120:121]
  v_pk_add_f32 v[98:99], v[98:99], v[122:123]
  v_pk_add_f32 v[100:101], v[100:101], v[124:125]
  v_pk_add_f32 v[102:103], v[102:103], v[126:127]
  v_cvt_pk_bf16_f32 v16, v96, v97
  v_lshlrev_b32 v96, 16, v16
  v_and_b32 v97, 0xffff0000, v16
  v_lshlrev_b32 v16, 16, v10
  v_and_b32 v17, 0xffff0000, v10
  v_pk_add_f32 v[96:97], v[96:97], v[16:17]
  v_cvt_pk_bf16_f32 v16, v96, v97
  v_lshlrev_b32 v96, 16, v16
  v_and_b32 v97, 0xffff0000, v16
  v_cvt_pk_bf16_f32 v16, v98, v99
  v_lshlrev_b32 v98, 16, v16
  v_and_b32 v99, 0xffff0000, v16
  v_lshlrev_b32 v16, 16, v11
  v_and_b32 v17, 0xffff0000, v11
  v_pk_add_f32 v[98:99], v[98:99], v[16:17]
  v_cvt_pk_bf16_f32 v16, v98, v99
  v_lshlrev_b32 v98, 16, v16
  v_and_b32 v99, 0xffff0000, v16
  v_cvt_pk_bf16_f32 v16, v100, v101
  v_lshlrev_b32 v100, 16, v16
  v_and_b32 v101, 0xffff0000, v16
  v_lshlrev_b32 v16, 16, v12
  v_and_b32 v17, 0xffff0000, v12
  v_pk_add_f32 v[100:101], v[100:101], v[16:17]
  v_cvt_pk_bf16_f32 v16, v100, v101
  v_lshlrev_b32 v100, 16, v16
  v_and_b32 v101, 0xffff0000, v16
  v_cvt_pk_bf16_f32 v16, v102, v103
  v_lshlrev_b32 v102, 16, v16
  v_and_b32 v103, 0xffff0000, v16
  v_lshlrev_b32 v16, 16, v13
  v_and_b32 v17, 0xffff0000, v13
  v_pk_add_f32 v[102:103], v[102:103], v[16:17]
  v_cvt_pk_bf16_f32 v16, v102, v103
  v_lshlrev_b32 v102, 16, v16
  v_and_b32 v103, 0xffff0000, v16
  s_mov_b32 s63, 0xc0135761
  v_mul_f32 v40, v96, v96
  v_mul_f32 v41, v97, v97
  v_mul_f32 v42, v98, v98
  v_mul_f32 v43, v99, v99
  v_mul_f32 v44, v100, v100
  v_mul_f32 v45, v101, v101
  v_mul_f32 v46, v102, v102
  v_mul_f32 v47, v103, v103
  v_mul_f32 v40, 0x3d372713, v40
  v_mul_f32 v41, 0x3d372713, v41
  v_mul_f32 v42, 0x3d372713, v42
  v_mul_f32 v43, 0x3d372713, v43
  v_mul_f32 v44, 0x3d372713, v44
  v_mul_f32 v45, 0x3d372713, v45
  v_mul_f32 v46, 0x3d372713, v46
  v_mul_f32 v47, 0x3d372713, v47
  v_fma_f32 v40, v40, v96, v96
  v_fma_f32 v41, v41, v97, v97
  v_fma_f32 v42, v42, v98, v98
  v_fma_f32 v43, v43, v99, v99
  v_fma_f32 v44, v44, v100, v100
  v_fma_f32 v45, v45, v101, v101
  v_fma_f32 v46, v46, v102, v102
  v_fma_f32 v47, v47, v103, v103
  v_mul_f32 v40, s63, v40
  v_mul_f32 v41, s63, v41
  v_mul_f32 v42, s63, v42
  v_mul_f32 v43, s63, v43
  v_mul_f32 v44, s63, v44
  v_mul_f32 v45, s63, v45
  v_mul_f32 v46, s63, v46
  v_mul_f32 v47, s63, v47
  v_exp_f32 v40, v40
  v_exp_f32 v41, v41
  v_exp_f32 v42, v42
  v_exp_f32 v43, v43
  v_exp_f32 v44, v44
  v_exp_f32 v45, v45
  v_exp_f32 v46, v46
  v_exp_f32 v47, v47
  v_add_f32 v40, 1.0, v40
  v_add_f32 v41, 1.0, v41
  v_add_f32 v42, 1.0, v42
  v_add_f32 v43, 1.0, v43
  v_add_f32 v44, 1.0, v44
  v_add_f32 v45, 1.0, v45
  v_add_f32 v46, 1.0, v46
  v_add_f32 v47, 1.0, v47
  v_rcp_f32 v40, v40
  v_rcp_f32 v41, v41
  v_rcp_f32 v42, v42
  v_rcp_f32 v43, v43
  v_rcp_f32 v44, v44
  v_rcp_f32 v45, v45
  v_rcp_f32 v46, v46
  v_rcp_f32 v47, v47
  v_mul_f32 v40, v96, v40
  v_mul_f32 v41, v97, v41
  v_mul_f32 v42, v98, v42
  v_mul_f32 v43, v99, v43
  v_mul_f32 v44, v100, v44
  v_mul_f32 v45, v101, v45
  v_mul_f32 v46, v102, v46
  v_mul_f32 v47, v103, v47
  v_cvt_pk_bf16_f32 v48, v40, v41
  v_cvt_pk_bf16_f32 v49, v42, v43
  v_cvt_pk_bf16_f32 v50, v44, v45
  v_cvt_pk_bf16_f32 v51, v46, v47
  ds_write_b64 v4, v[48:49] offset:37120
  ds_write_b64 v4, v[50:51] offset:37248
  s_lshl_b32 s60, s4, 1
  s_add_u32 s60, s60, s56
  s_lshl_b32 s60, s60, 13
  s_lshl_b32 s63, s93, 8
  s_add_u32 s60, s60, s63
  s_add_u32 s60, s60, 401408
  s_waitcnt lgkmcnt(0)
  ds_read_b128 v[96:99], v8 offset:37120
  ds_read_b64_tr_b16 v[100:101], v38 offset:16384
  ds_read_b64_tr_b16 v[102:103], v38 offset:16896
  ds_read_b64_tr_b16 v[104:105], v38 offset:16392
  ds_read_b64_tr_b16 v[106:107], v38 offset:16904
  ds_read_b64_tr_b16 v[108:109], v38 offset:16400
  ds_read_b64_tr_b16 v[110:111], v38 offset:16912
  ds_read_b64_tr_b16 v[112:113], v38 offset:16408
  ds_read_b64_tr_b16 v[114:115], v38 offset:16920
  s_waitcnt lgkmcnt(0)
  ds_read_b128 v[116:119], v8 offset:37184
  ds_read_b64_tr_b16 v[120:121], v38 offset:20480
  ds_read_b64_tr_b16 v[122:123], v38 offset:20992
  ds_read_b64_tr_b16 v[124:125], v38 offset:20488
  ds_read_b64_tr_b16 v[126:127], v38 offset:21000
  ds_read_b64_tr_b16 v[128:129], v38 offset:20496
  ds_read_b64_tr_b16 v[130:131], v38 offset:21008
  ds_read_b64_tr_b16 v[132:133], v38 offset:20504
  ds_read_b64_tr_b16 v[134:135], v38 offset:21016
  v_mfma_f32_16x16x32_bf16 v[72:75], v[100:103], v[96:99], 0
  v_mfma_f32_16x16x32_bf16 v[76:79], v[104:107], v[96:99], 0
  v_mfma_f32_16x16x32_bf16 v[80:83], v[108:111], v[96:99], 0
  v_mfma_f32_16x16x32_bf16 v[84:87], v[112:115], v[96:99], 0
  s_waitcnt lgkmcnt(0)
  ds_read_b128 v[96:99], v8 offset:37248
  ds_read_b64_tr_b16 v[100:101], v38 offset:24576
  ds_read_b64_tr_b16 v[102:103], v38 offset:25088
  ds_read_b64_tr_b16 v[104:105], v38 offset:24584
  ds_read_b64_tr_b16 v[106:107], v38 offset:25096
  ds_read_b64_tr_b16 v[108:109], v38 offset:24592
  ds_read_b64_tr_b16 v[110:111], v38 offset:25104
  ds_read_b64_tr_b16 v[112:113], v38 offset:24600
  ds_read_b64_tr_b16 v[114:115], v38 offset:25112
  v_mfma_f32_16x16x32_bf16 v[72:75], v[120:123], v[116:119], v[72:75]
  v_mfma_f32_16x16x32_bf16 v[76:79], v[124:127], v[116:119], v[76:79]
  v_mfma_f32_16x16x32_bf16 v[80:83], v[128:131], v[116:119], v[80:83]
  v_mfma_f32_16x16x32_bf16 v[84:87], v[132:135], v[116:119], v[84:87]
  s_waitcnt lgkmcnt(0)
  ds_read_b128 v[116:119], v8 offset:37312
  ds_read_b64_tr_b16 v[120:121], v38 offset:28672
  ds_read_b64_tr_b16 v[122:123], v38 offset:29184
  ds_read_b64_tr_b16 v[124:125], v38 offset:28680
  ds_read_b64_tr_b16 v[126:127], v38 offset:29192
  ds_read_b64_tr_b16 v[128:129], v38 offset:28688
  ds_read_b64_tr_b16 v[130:131], v38 offset:29200
  ds_read_b64_tr_b16 v[132:133], v38 offset:28696
  ds_read_b64_tr_b16 v[134:135], v38 offset:29208
  v_mfma_f32_16x16x32_bf16 v[72:75], v[100:103], v[96:99], v[72:75]
  v_mfma_f32_16x16x32_bf16 v[76:79], v[104:107], v[96:99], v[76:79]
  v_mfma_f32_16x16x32_bf16 v[80:83], v[108:111], v[96:99], v[80:83]
  v_mfma_f32_16x16x32_bf16 v[84:87], v[112:115], v[96:99], v[84:87]
  s_waitcnt lgkmcnt(0)
  v_mfma_f32_16x16x32_bf16 v[72:75], v[120:123], v[116:119], v[72:75]
  v_mfma_f32_16x16x32_bf16 v[76:79], v[124:127], v[116:119], v[76:79]
  v_mfma_f32_16x16x32_bf16 v[80:83], v[128:131], v[116:119], v[80:83]
  v_mfma_f32_16x16x32_bf16 v[84:87], v[132:135], v[116:119], v[84:87]
  v_bfe_u32 v16, v0, 2, 2
  v_and_b32 v17, 3, v0
  v_mul_u32_u24 v16, 2048, v16
  v_lshl_or_b32 v17, v2, 2, v17
  v_lshl_add_u32 v4, v17, 4, v16
  s_nop 0
  v_cndmask_b32 v72, v72, v76, s[16:17]
  v_cndmask_b32 v73, v73, v77, s[16:17]
  v_cndmask_b32 v74, v74, v78, s[16:17]
  v_cndmask_b32 v75, v75, v79, s[16:17]
  v_cndmask_b32 v72, v72, v80, s[18:19]
  v_cndmask_b32 v73, v73, v81, s[18:19]
  v_cndmask_b32 v74, v74, v82, s[18:19]
  v_cndmask_b32 v75, v75, v83, s[18:19]
  v_cndmask_b32 v72, v72, v84, s[14:15]
  v_cndmask_b32 v73, v73, v85, s[14:15]
  v_cndmask_b32 v74, v74, v86, s[14:15]
  v_cndmask_b32 v75, v75, v87, s[14:15]
  v_bfi_b32 v72, s10, v5, v72
  v_bfi_b32 v73, s10, v5, v73
  v_bfi_b32 v74, s10, v5, v74
  v_bfi_b32 v75, s10, v5, v75
  buffer_store_dwordx4 v[72:75], v4, s[20:23], s60 offen sc1
L_no_m2:
  v_bfe_u32 v16, v0, 1, 4
  v_and_b32 v17, 1, v0
  v_lshlrev_b32 v17, 4, v17
  v_lshl_or_b32 v3, v16, 13, v17
  s_lshl_b32 s60, s62, 1
  s_add_u32 s60, s60, 401408
  v_mov_b32 v17, 0
L_lds7:
  s_sleep 4
  ds_read_b32 v16, v17 offset:42560
  s_waitcnt lgkmcnt(0)
  v_cmp_gt_u32 vcc, 2, v16
  s_cbranch_vccnz L_lds7
  buffer_load_dwordx4 v[32:35], v3, s[20:23], s60 offen sc1
  s_mov_b32 s94, 1048576
L_poll8:
  s_waitcnt vmcnt(0)
  v_xor_b32 v32, v5, v32
  v_xor_b32 v33, v5, v33
  v_xor_b32 v34, v5, v34
  v_xor_b32 v35, v5, v35
  v_or3_b32 v16, v32, v33, v34
  v_bitop3_b32 v16, v16, v35, s10 bitop3:0xa8
  v_cmp_ne_u32 vcc, 0, v16
  s_cbranch_vccz L_poll8_done
  s_sleep 32
  s_mov_b64 exec, vcc
  buffer_load_dwordx4 v[32:35], v3, s[20:23], s60 offen sc1
  s_sub_u32 s94, s94, 1
  s_cbranch_scc0 L_poll8
  s_waitcnt vmcnt(0)
L_poll8_done:
  s_mov_b64 exec, -1
  s_cmp_lg_u32 s2, 0
  s_cbranch_scc1 L_no_epoch
  s_mov_b64 exec, 1
  buffer_store_dword v6, v39, s[20:23], 0 offen sc1
  s_mov_b64 exec, -1
L_no_epoch:
  v_lshlrev_b32 v20, 4, v0
  v_bfe_u32 v23, v0, 3, 2
  v_xor_b32 v23, v0, v23
  v_lshlrev_b32 v23, 4, v23
  v_lshlrev_b32 v24, 5, v2
  v_lshlrev_b32 v21, 4, v2
  s_lshl_b32 s60, s6, 3
  s_add_u32 s60, s60, s4
  s_mul_i32 s52, s60, 17408
  s_add_u32 s52, s52, 532480
  s_mul_i32 s60, s7, 2176
  s_add_u32 s60, s60, s52
  v_bfe_u32 v16, v0, 1, 3
  v_mul_u32_u24 v16, 2176, v16
  v_and_b32 v17, 1, v0
  v_lshl_add_u32 v16, v17, 7, v16
  s_lshr_b32 s54, s7, 1
  s_and_b32 s53, s7, 1
  s_lshl_b32 s54, s54, 8
  s_lshl_b32 s53, s53, 10
  s_add_u32 s54, s54, s53
  v_add_u32 v16, s54, v16
  v_and_b32 v17, 7, v0
  v_mul_u32_u24 v17, 2176, v17
  v_add_u32 v17, 2048, v17
  v_cmp_gt_u32 vcc, 16, v0
  s_nop 1
  v_cndmask_b32 v18, v17, v16, vcc
  v_mov_b32 v17, 0
L_lds9:
  s_sleep 4
  ds_read_b32 v16, v17 offset:42560
  s_waitcnt lgkmcnt(0)
  v_cmp_gt_u32 vcc, 3, v16
  s_cbranch_vccnz L_lds9
  s_mov_b32 exec_lo, 0xffffff
  s_mov_b32 exec_hi, 0
  buffer_load_dword v19, v18, s[20:23], s52 offen sc1
  s_mov_b64 exec, -1
  v_mov_b32 v17, 0
L_lds10:
  s_sleep 1
  ds_read_b32 v16, v17 offset:42568
  s_waitcnt lgkmcnt(0)
  v_cmp_gt_u32 vcc, 4, v16
  s_cbranch_vccnz L_lds10
  s_setprio 3
  ds_read_b128 v[40:43], v24 offset:50944
  ds_read_b128 v[44:47], v24 offset:50960
  s_waitcnt lgkmcnt(0)
  v_max3_f32 v16, v40, v42, v44
  v_max_f32 v16, v16, v46
  v_and_b32 v16, 0xfffffc00, v16
  v_or_b32 v80, v5, v16
  v_sub_f32 v40, v40, v16
  v_sub_f32 v42, v42, v16
  v_sub_f32 v44, v44, v16
  v_sub_f32 v46, v46, v16
  v_exp_f32 v40, v40
  v_exp_f32 v42, v42
  v_exp_f32 v44, v44
  v_exp_f32 v46, v46
  v_mov_b32 v82, v80
  v_mul_f32 v16, v40, v41
  v_fmac_f32 v16, v42, v43
  v_fmac_f32 v16, v44, v45
  v_fmac_f32 v16, v46, v47
  v_bfi_b32 v81, s10, v5, v16
  v_bfi_b32 v83, s10, v5, v16
  s_mov_b32 exec_lo, 0x00010001
  s_mov_b32 exec_hi, 0x00010001
  s_cmp_eq_u64 s[12:13], 0
  s_cbranch_scc0 L_far11
  buffer_store_dwordx4 v[80:83], v21, s[20:23], s60 offen offset:2048
L_near11:
  s_mov_b64 exec, -1
  s_barrier
  ds_read_b128 v[48:51], v23 offset:42752
  ds_read_b128 v[52:55], v23 offset:43776
  ds_read_b128 v[56:59], v23 offset:44800
  ds_read_b128 v[60:63], v23 offset:45824
  ds_read_b128 v[64:67], v23 offset:46848
  ds_read_b128 v[68:71], v23 offset:47872
  ds_read_b128 v[72:75], v23 offset:48896
  ds_read_b128 v[76:79], v23 offset:49920
  s_waitcnt lgkmcnt(6)
  v_pk_mul_f32 v[48:49], v[48:49], v[40:41] op_sel_hi:[1,0]
  v_pk_mul_f32 v[50:51], v[50:51], v[40:41] op_sel_hi:[1,0]
  v_pk_mul_f32 v[52:53], v[52:53], v[40:41] op_sel_hi:[1,0]
  v_pk_mul_f32 v[54:55], v[54:55], v[40:41] op_sel_hi:[1,0]
  s_waitcnt lgkmcnt(4)
  v_pk_fma_f32 v[48:49], v[56:57], v[42:43], v[48:49] op_sel_hi:[1,0,1]
  v_pk_fma_f32 v[50:51], v[58:59], v[42:43], v[50:51] op_sel_hi:[1,0,1]
  v_pk_fma_f32 v[52:53], v[60:61], v[42:43], v[52:53] op_sel_hi:[1,0,1]
  v_pk_fma_f32 v[54:55], v[62:63], v[42:43], v[54:55] op_sel_hi:[1,0,1]
  s_waitcnt lgkmcnt(2)
  v_pk_fma_f32 v[48:49], v[64:65], v[44:45], v[48:49] op_sel_hi:[1,0,1]
  v_pk_fma_f32 v[50:51], v[66:67], v[44:45], v[50:51] op_sel_hi:[1,0,1]
  v_pk_fma_f32 v[52:53], v[68:69], v[44:45], v[52:53] op_sel_hi:[1,0,1]
  v_pk_fma_f32 v[54:55], v[70:71], v[44:45], v[54:55] op_sel_hi:[1,0,1]
  s_waitcnt lgkmcnt(0)
  v_pk_fma_f32 v[48:49], v[72:73], v[46:47], v[48:49] op_sel_hi:[1,0,1]
  v_pk_fma_f32 v[50:51], v[74:75], v[46:47], v[50:51] op_sel_hi:[1,0,1]
  v_pk_fma_f32 v[52:53], v[76:77], v[46:47], v[52:53] op_sel_hi:[1,0,1]
  v_pk_fma_f32 v[54:55], v[78:79], v[46:47], v[54:55] op_sel_hi:[1,0,1]
  v_bfi_b32 v48, s10, v5, v48
  v_bfi_b32 v49, s10, v5, v49
  v_bfi_b32 v50, s10, v5, v50
  v_bfi_b32 v51, s10, v5, v51
  v_bfi_b32 v52, s10, v5, v52
  v_bfi_b32 v53, s10, v5, v53
  v_bfi_b32 v54, s10, v5, v54
  v_bfi_b32 v55, s10, v5, v55
  s_cmp_eq_u64 s[12:13], 0
  s_cbranch_scc0 L_far12
  buffer_store_dwordx4 v[48:51], v20, s[20:23], s60 offen
  buffer_store_dwordx4 v[52:55], v20, s[20:23], s60 offen offset:1024
L_near12:
  s_barrier
  v_cmp_lt_u32 vcc, 31, v0
  s_nop 1
  v_cndmask_b32 v30, v32, v34, vcc
  v_cndmask_b32 v31, v33, v35, vcc
  s_nop 1
  v_permlane16_swap_b32 v30, v31
  v_add_f32 v30, v30, v31
  s_nop 1
  v_add_f32_dpp v30, v30, v30 row_ror:2 row_mask:0xf bank_mask:0xf
  s_nop 1
  v_add_f32_dpp v30, v30, v30 row_ror:4 row_mask:0xf bank_mask:0xf
  s_nop 1
  v_add_f32_dpp v30, v30, v30 row_ror:8 row_mask:0xf bank_mask:0xf
  v_cvt_pk_bf16_f32 v30, v30, v30
  v_lshlrev_b32 v30, 16, v30
  v_lshlrev_b32 v16, 16, v15
  v_add_f32 v30, v30, v16
  v_cvt_pk_bf16_f32 v30, v30, v30
  v_lshlrev_b32 v30, 16, v30
  v_mul_f32 v16, 0xbfb8aa3b, v30
  v_exp_f32 v16, v16
  s_nop 0
  v_add_f32 v16, 1.0, v16
  v_rcp_f32 v16, v16
  s_nop 0
  v_mul_f32 v30, v30, v16
  v_cvt_pk_bf16_f32 v30, v30, v30
  v_lshlrev_b32 v30, 16, v30
  v_lshlrev_b32 v31, 16, v14
  v_lshrrev_b32 v22, 1, v0
  v_and_b32 v17, 1, v0
  v_lshlrev_b32 v17, 4, v17
  v_lshl_or_b32 v22, v22, 11, v17
  s_lshl_b32 s57, s6, 17
  s_lshl_b32 s58, s61, 1
  s_add_u32 s57, s57, s58
  s_add_u32 s57, s57, 1114112
  s_add_u32 s56, s57, 0x10000
  buffer_load_dwordx4 v[88:91], v22, s[20:23], s57 offen sc1
  buffer_load_dwordx4 v[92:95], v22, s[20:23], s56 offen sc1
  s_mov_b32 s94, 1048576
L_poll13:
  s_waitcnt vmcnt(0)
  v_xor_b32 v88, v5, v88
  v_xor_b32 v89, v5, v89
  v_xor_b32 v90, v5, v90
  v_xor_b32 v91, v5, v91
  v_xor_b32 v92, v5, v92
  v_xor_b32 v93, v5, v93
  v_xor_b32 v94, v5, v94
  v_xor_b32 v95, v5, v95
  v_or3_b32 v16, v88, v89, v90
  v_or3_b32 v16, v16, v91, v92
  v_or3_b32 v16, v16, v93, v94
  v_bitop3_b32 v16, v16, v95, s10 bitop3:0xa8
  v_cmp_ne_u32 vcc, 0, v16
  s_cbranch_vccz L_poll13_done
  s_mov_b64 exec, vcc
  buffer_load_dwordx4 v[88:91], v22, s[20:23], s57 offen sc1
  buffer_load_dwordx4 v[92:95], v22, s[20:23], s56 offen sc1
  s_sub_u32 s94, s94, 1
  s_cbranch_scc0 L_poll13
  s_waitcnt vmcnt(0)
L_poll13_done:
  s_mov_b64 exec, -1
  v_pk_add_f32 v[40:41], v[88:89], v[92:93]
  v_pk_add_f32 v[42:43], v[90:91], v[94:95]
  s_nop 1
  v_permlane32_swap_b32 v40, v42
  v_permlane32_swap_b32 v41, v43
  v_pk_add_f32 v[40:41], v[40:41], v[42:43]
  s_nop 1
  v_permlane16_swap_b32 v40, v41
  v_add_f32 v40, v40, v41
  s_nop 1
  v_add_f32_dpp v40, v40, v40 row_ror:2 row_mask:0xf bank_mask:0xf
  s_nop 1
  v_add_f32_dpp v40, v40, v40 row_ror:4 row_mask:0xf bank_mask:0xf
  s_nop 1
  v_add_f32_dpp v40, v40, v40 row_ror:8 row_mask:0xf bank_mask:0xf
  s_mov_b32 exec_lo, 0x00030003
  s_mov_b32 exec_hi, 0x00030003
  v_fma_f32 v40, v40, v30, v31
  v_cvt_pk_bf16_f32 v40, v40, v40
  buffer_store_short v40, v39, s[44:47], s62 offen
L_end:
  s_endpgm
L_far4:
  buffer_store_dwordx4 v[72:75], v4, s[20:23], s60 offen sc1
  s_branch L_near4
L_far11:
  buffer_store_dwordx4 v[80:83], v21, s[20:23], s60 offen offset:2048 sc1
  s_branch L_near11
L_far12:
  buffer_store_dwordx4 v[48:51], v20, s[20:23], s60 offen sc1
  buffer_store_dwordx4 v[52:55], v20, s[20:23], s60 offen offset:1024 sc1
  s_branch L_near12
L_code_end:
.section .rodata,"a"
.p2align 6
.amdhsa_kernel recurrent_scan__gqa_block_cached__mixer_channel_mlp__decode_kernel
  .amdhsa_next_free_vgpr 256
  .amdhsa_next_free_sgpr 102
  .amdhsa_accum_offset 256
  .amdhsa_group_segment_fixed_size 0
  .amdhsa_kernarg_size 104
  .amdhsa_user_sgpr_count 2
  .amdhsa_user_sgpr_kernarg_segment_ptr 1
  .amdhsa_system_sgpr_workgroup_id_x 1
  .amdhsa_float_denorm_mode_32 3
.end_amdhsa_kernel
```
